```python
import torch

def _softmax(x, axis=-1):
    return torch.softmax(x, dim=axis)
def _gelu(x):
    return torch.nn.functional.gelu(x, approximate="tanh")
def _silu(x):
    return torch.nn.functional.silu(x)
def _sigmoid(x):
    return torch.sigmoid(x)
def _layernorm(x, axis=-1, eps=1e-5):
    m = x.mean(dim=axis, keepdim=True)
    v = x.var(dim=axis, keepdim=True, unbiased=False)
    return (x - m) / torch.sqrt(v + eps)
def _scatter_add(tgt, idx, src, axis=0):
    return tgt.clone().index_add_(axis, idx, src)
def _segment_sum(src, seg, n):
    out = torch.zeros((n,) + src.shape[1:], dtype=src.dtype)
    return out.index_add_(0, seg, src)
def _pad(x, pw):
    flat = tuple(v for pair in reversed(pw) for v in pair)
    return torch.nn.functional.pad(x, flat)

kernel_name = 'recurrent_scan__sliding_block__geglu_ffn__prompt'

def setup_inputs():

    _w = (lambda a: (lambda t: t.to(torch.bfloat16) if t.is_floating_point() else t)(torch.as_tensor(a)))
    def _A_setup():
        B, S, D = 1, 2048, 512
        return {
            "x": _w((lambda *s: torch.randn(*s, dtype=torch.bfloat16) * 0.05)(B, S, D)),
            "wqkv": _w((lambda *s: torch.randn(*s, dtype=torch.bfloat16) * 0.05)(D, 3 * D)),
            "wo": _w((lambda *s: torch.randn(*s, dtype=torch.bfloat16) * 0.05)(D, D)),
        }
    _A_in = _A_setup()

    def _B_setup():
        B, S, D, F = 1, 2048, 512, 1792
        return {
            "x": _w((lambda *s: torch.randn(*s, dtype=torch.bfloat16) * 0.05)(B, S, D)),
            "w_gate": _w((lambda *s: torch.randn(*s, dtype=torch.bfloat16) * 0.05)(D, F)),
            "w_up": _w((lambda *s: torch.randn(*s, dtype=torch.bfloat16) * 0.05)(D, F)),
            "w_down": _w((lambda *s: torch.randn(*s, dtype=torch.bfloat16) * 0.05)(F, D)),
        }
    _B_in = _B_setup()

    return {
        "A_x": _A_in["x"],
        "A_wqkv": _A_in["wqkv"],
        "A_wo": _A_in["wo"],
        "B_x": _B_in["x"],
        "B_w_gate": _B_in["w_gate"],
        "B_w_up": _B_in["w_up"],
        "B_w_down": _B_in["w_down"],
    }

def reference(A_x, A_wqkv, A_wo, B_x, B_w_gate, B_w_up, B_w_down):
    def _A_ref(x, wqkv, wo):
        B, S, D = x.shape
        H = 32; Dh = D // H; W = 256
        qkv = (lambda x, *d: x.permute(*d))((x @ wqkv).reshape(B, S, 3, H, Dh), 2, 0, 3, 1, 4)
        q, k, v = qkv[0], qkv[1], qkv[2]
        scores = torch.einsum("bhqd,bhkd->bhqk", q, k) * (Dh ** -0.5)
        idx = torch.arange(S)
        mask = (idx[:, None] - idx[None, :] >= 0) & (idx[:, None] - idx[None, :] < W)
        scores = torch.where(mask[None, None], scores, -1e9)
        p = _softmax(scores, axis=-1)
        o = torch.einsum("bhqk,bhkd->bhqd", p, v)
        return (lambda x, *d: x.permute(*d))(o, 0, 2, 1, 3).reshape(B, S, D) @ wo

    def _B_ref(x, w_gate, w_up, w_down):
        return (_gelu(x @ w_gate) * (x @ w_up)) @ w_down

    x = A_x
    xn = _layernorm(x, axis=-1)
    s = _A_ref(xn, A_wqkv, A_wo)
    g = _silu(_B_ref(xn, B_w_gate, B_w_up, B_w_down))
    return x + s * g
```

```asm
; @launch grid=(256,1,1) block=(512,1,1) lds=163840
.amdgcn_target "amdgcn-amd-amdhsa--gfx950"
.text
.globl recurrent_scan__sliding_block__geglu_ffn__prompt_kernel
.p2align 8
.type recurrent_scan__sliding_block__geglu_ffn__prompt_kernel,@function
recurrent_scan__sliding_block__geglu_ffn__prompt_kernel:
  s_cmp_ge_u32 s2, 256
  s_cbranch_scc1 L_end
  s_load_dwordx16 s[4:19], s[0:1], 0
  s_load_dwordx4 s[20:23], s[0:1], 64
  s_cmp_ge_u32 s2, 32
  s_cbranch_scc1 L_npf
  s_getpc_b64 s[92:93]
L_pc:
  s_and_b32 s92, s92, 0xffffff00
  s_and_b32 s93, s93, 0xffff
  s_mov_b32 s94, (L_code_end - L_pc)
  s_mov_b32 s95, 0x20000
  v_lshlrev_b32 v36, 7, v0
  buffer_load_dword v73, v36, s[92:95], 0 offen
L_npf:
  v_lshrrev_b32 v36, 6, v0
  v_and_b32 v0, 63, v0
  v_readfirstlane_b32 s56, v36
  s_and_b32 s68, s2, 7
  s_lshr_b32 s69, s2, 3
  s_and_b32 s59, s68, 1
  s_lshl_b32 s59, s59, 3
  s_and_b32 s63, s69, 7
  s_add_u32 s59, s59, s63
  s_lshr_b32 s60, s68, 1
  s_lshr_b32 s61, s69, 3
  s_lshl_b32 s91, s61, 1
  s_add_u32 s91, s91, s63
  s_and_b32 s91, s91, 0
  s_lshl_b32 s72, s56, 11
  s_lshl_b32 s73, s56, 10
  s_lshl_b32 s76, s59, 17
  s_mul_i32 s68, s60, 3
  s_add_u32 s69, s68, s61
  s_add_u32 s70, s68, 12
  s_mov_b32 s78, s69
  s_add_u32 s71, s78, 12
  s_add_u32 s75, s60, 24
  s_movk_i32 s64, 3584
  s_cmp_eq_u32 s61, 3
  s_cselect_b32 s62, 1, 0
  s_cselect_b32 s74, s70, s69
  s_cselect_b32 s75, s75, s71
  s_cselect_b32 s64, 3072, s64
  v_lshrrev_b32 v36, 3, v0
  v_and_b32 v37, 7, v0
  v_lshrrev_b32 v38, 4, v0
  v_xor_b32 v39, v37, v38
  s_lshl_b32 s68, s56, 4
  v_add_u32 v40, s68, v36
  v_lshlrev_b32 v40, 10, v40
  v_lshl_add_u32 v1, v39, 4, v40
  v_xor_b32 v2, 64, v1
  v_add_u32 v2, 0x2000, v2
  s_lshl_b32 s68, s56, 3
  v_add_u32 v40, s68, v36
  v_and_b32 v38, 1, v38
  v_lshlrev_b32 v38, 2, v38
  v_xor_b32 v41, v37, v38
  v_lshlrev_b32 v41, 4, v41
  v_mul_u32_u24 v3, 3072, v40
  v_add_u32 v3, v3, v41
  v_mul_u32_u24 v5, 3584, v40
  v_add_u32 v5, v5, v41
  v_mul_u32_u24 v4, s64, v40
  v_add_u32 v4, v4, v41
  s_lshl_b32 s64, s64, 6
  s_mov_b32 s26, 2097152
  s_mov_b32 s27, 0x20000
  s_mov_b32 s31, 0x20000
  s_mov_b32 s35, 0x20000
  s_mov_b32 s39, 0x20000
  s_waitcnt lgkmcnt(0)
  s_mov_b32 s24, s4
  s_and_b32 s25, s5, 0xffff
  s_lshl_b32 s68, s74, 7
  s_add_u32 s28, s6, s68
  s_addc_u32 s29, s7, 0
  s_and_b32 s29, s29, 0xffff
  s_sub_u32 s30, 1572864, s68
  s_lshl_b32 s68, s78, 7
  s_add_u32 s69, s74, 1
  s_lshl_b32 s69, s69, 7
  s_mov_b32 s34, 1835008
  s_cmp_eq_u32 s62, 1
  s_cselect_b32 s68, s69, s68
  s_cselect_b32 s32, s6, s12
  s_cselect_b32 s33, s7, s13
  s_cselect_b32 s34, 1572864, s34
  s_add_u32 s32, s32, s68
  s_addc_u32 s33, s33, 0
  s_and_b32 s33, s33, 0xffff
  s_sub_u32 s34, s34, s68
  s_lshl_b32 s68, s78, 7
  s_add_u32 s69, s74, 2
  s_lshl_b32 s69, s69, 7
  s_mov_b32 s38, 1835008
  s_cmp_eq_u32 s62, 1
  s_cselect_b32 s68, s69, s68
  s_cselect_b32 s36, s6, s14
  s_cselect_b32 s37, s7, s15
  s_cselect_b32 s38, 1572864, s38
  s_add_u32 s36, s36, s68
  s_addc_u32 s37, s37, 0
  s_and_b32 s37, s37, 0xffff
  s_sub_u32 s38, s38, s68
  s_add_u32 s65, s76, 0
  s_mov_b32 s66, 0
  s_mul_i32 s67, s64, 0
  s_add_u32 m0, s72, 0
  s_nop 0
  buffer_load_dwordx4 v1, s[24:27], s65 offen lds
  s_add_u32 m0, s72, 1024
  s_nop 0
  buffer_load_dwordx4 v2, s[24:27], s65 offen lds
  s_add_u32 m0, s73, 16384
  s_nop 0
  buffer_load_dwordx4 v3, s[28:31], s66 offen lds
  s_add_u32 m0, s73, 24576
  s_nop 0
  buffer_load_dwordx4 v4, s[32:35], s67 offen lds
  s_add_u32 m0, s73, 32768
  s_nop 0
  buffer_load_dwordx4 v4, s[36:39], s67 offen lds
  s_lshl_b32 s68, s75, 7
  s_add_u32 s40, s12, s68
  s_addc_u32 s41, s13, 0
  s_and_b32 s41, s41, 0xffff
  s_sub_u32 s42, 1835008, s68
  s_mov_b32 s43, 0x20000
  s_lshl_b32 s68, s75, 7
  s_add_u32 s44, s14, s68
  s_addc_u32 s45, s15, 0
  s_and_b32 s45, s45, 0xffff
  s_sub_u32 s46, 1835008, s68
  s_mov_b32 s47, 0x20000
  s_mov_b32 s48, s22
  s_and_b32 s49, s23, 0xffff
  s_mov_b32 s50, 15745024
  s_mov_b32 s51, 0x20000
  s_mov_b32 s52, s20
  s_and_b32 s53, s21, 0xffff
  s_movk_i32 s54, 256
  s_mov_b32 s55, 0x20000
  s_lshr_b32 s57, s56, 1
  s_and_b32 s58, s56, 1
  s_or_b32 s68, s2, s56
  s_cmp_eq_u32 s68, 0
  s_cbranch_scc1 R1
B1:
  s_and_b32 s68, s57, 1
  s_lshl_b32 s68, s68, 1
  s_lshr_b32 s69, s57, 1
  s_xor_b32 s69, s69, s58
  s_add_u32 s68, s68, s69
  v_and_b32 v36, 31, v0
  v_lshrrev_b32 v37, 5, v0
  v_bfe_u32 v38, v0, 1, 3
  v_xor_b32 v38, v38, v37
  v_lshlrev_b32 v38, 4, v38
  v_lshl_add_u32 v38, v36, 7, v38
  s_lshl_b32 s69, s57, 12
  v_add_u32 v38, s69, v38
  s_lshl_b32 s69, s68, 5
  v_xor_b32 v6, s69, v38
  v_xor_b32 v7, 32, v6
  v_xor_b32 v8, 64, v6
  v_xor_b32 v9, 0x60, v6
  v_bfe_u32 v38, v0, 2, 2
  v_lshl_add_u32 v39, v37, 3, v38
  v_lshlrev_b32 v39, 7, v39
  v_lshrrev_b32 v38, 1, v38
  v_xor_b32 v38, s58, v38
  v_lshl_add_u32 v39, v38, 6, v39
  v_bfe_u32 v38, v0, 4, 1
  v_lshl_add_u32 v39, v38, 5, v39
  v_and_b32 v38, 3, v0
  v_lshl_add_u32 v39, v38, 3, v39
  s_lshl_b32 s69, s68, 11
  v_xor_b32 v10, s69, v39
  v_xor_b32 v11, 0x800, v10
  v_xor_b32 v12, 0x1000, v10
  v_xor_b32 v13, 0x1800, v10
  v_lshlrev_b32 v72, 4, v0
  v_lshrrev_b32 v38, 4, v0
  v_xor_b32 v38, v38, v0
  v_and_b32 v38, 1, v38
  v_cmp_eq_u32 vcc, 0, v38
  v_mov_b32 v39, 0x3f803f80
  s_nop 0
  v_cndmask_b32 v20, 0, v39, vcc
  v_mov_b32 v21, v20
  v_mov_b32 v22, v20
  v_mov_b32 v23, v20
  v_mov_b32 v40, v39
  v_mov_b32 v41, v39
  v_mov_b32 v42, v39
  v_mov_b32 v43, v39
  v_add_u32 v36, 159872, v72
  ds_write_b128 v36, v[40:43]
  v_mov_b32 v14, 0
  v_mov_b32 v15, 0
  v_mov_b32 v16, 0
  v_mov_b32 v17, 0
  s_add_u32 s65, s76, 128
  s_mov_b32 s66, 196608
  s_mul_i32 s67, s64, 1
  s_add_u32 m0, s72, 40960
  s_nop 0
  buffer_load_dwordx4 v1, s[24:27], s65 offen lds
  s_add_u32 m0, s72, 41984
  s_nop 0
  buffer_load_dwordx4 v2, s[24:27], s65 offen lds
  s_add_u32 m0, s73, 57344
  s_nop 0
  buffer_load_dwordx4 v3, s[28:31], s66 offen lds
  s_add_u32 m0, s73, 65536
  s_nop 0
  buffer_load_dwordx4 v4, s[32:35], s67 offen lds
  s_add_u32 m0, s73, 73728
  s_nop 0
  buffer_load_dwordx4 v4, s[36:39], s67 offen lds
  v_and_b32 v74, 3, v0
  v_lshlrev_b32 v74, 7, v74
  s_lshr_b32 s99, s2, 3
  s_lshl_b32 s99, s99, 3
  s_add_u32 s99, s99, s56
  s_lshl_b32 s99, s99, 10
  s_and_b32 s68, s2, 1
  s_lshl_b32 s68, s68, 9
  s_add_u32 s99, s99, s68
  v_add_u32 v74, s99, v74
  s_mov_b32 s20, s8
  s_and_b32 s21, s9, 0xffff
  s_mov_b32 s22, 524288
  s_mov_b32 s23, 0x20000
  v_lshrrev_b32 v76, 4, v0
  v_lshlrev_b32 v76, 4, v76
  v_and_b32 v77, 1, v0
  v_lshl_add_u32 v76, v77, 6, v76
  s_lshl_b32 s68, s58, 2
  s_add_u32 s68, s68, s57
  s_mul_i32 s68, s68, 384
  s_add_u32 s68, s68, 122880
  v_add_u32 v76, s68, v76
  v_min_u32 v77, 47, v0
  v_lshlrev_b32 v77, 3, v77
  s_mul_i32 s68, s58, 384
  s_add_u32 s68, s68, 125952
  v_add_u32 v78, s68, v77
  s_mul_i32 s69, s58, 1536
  s_add_u32 s69, s69, 122880
  v_add_u32 v77, s69, v77
  v_lshrrev_b32 v79, 5, v0
  v_lshlrev_b32 v79, 4, v79
  v_add_u32 v79, s68, v79
  s_waitcnt vmcnt(5)
  s_waitcnt lgkmcnt(0)
  s_barrier
X_begin:
  ds_read_b128 v[128:131], v6
  ds_read_b64_tr_b16 v[36:37], v10 offset:16384
  ds_read_b64_tr_b16 v[38:39], v10 offset:16896
  ds_read_b64_tr_b16 v[40:41], v10 offset:24576
  ds_read_b64_tr_b16 v[42:43], v10 offset:25088
  ds_read_b64_tr_b16 v[44:45], v10 offset:32768
  ds_read_b64_tr_b16 v[46:47], v10 offset:33280
  ds_read_b128 v[132:135], v7
  ds_read_b64_tr_b16 v[48:49], v11 offset:16384
  ds_read_b64_tr_b16 v[50:51], v11 offset:16896
  ds_read_b64_tr_b16 v[52:53], v11 offset:24576
  ds_read_b64_tr_b16 v[54:55], v11 offset:25088
  ds_read_b64_tr_b16 v[56:57], v11 offset:32768
  ds_read_b64_tr_b16 v[58:59], v11 offset:33280
  s_waitcnt lgkmcnt(7)
  v_mfma_f32_32x32x16_bf16 v[80:95], v[36:39], v[128:131], 0
  s_add_u32 s65, s76, 256
  s_mov_b32 s66, 393216
  s_mul_i32 s67, s64, 2
  s_add_u32 m0, s72, 81920
  v_lshlrev_b32 v18, 16, v128
  v_and_b32 v19, 0xffff0000, v128
  v_add_f32 v14, v14, v18
  ds_read_b128 v[136:139], v8
  ds_read_b64_tr_b16 v[60:61], v12 offset:16384
  buffer_load_dwordx4 v1, s[24:27], s65 offen lds
  v_mfma_f32_16x16x32_bf16 v[24:27], v[36:39], v[20:23], 0
  v_add_f32 v15, v15, v19
  v_fmac_f32 v16, v18, v18
  v_fmac_f32 v17, v19, v19
  ds_read_b64_tr_b16 v[62:63], v12 offset:16896
  ds_read_b64_tr_b16 v[64:65], v12 offset:24576
  v_mfma_f32_32x32x16_bf16 v[96:111], v[40:43], v[128:131], 0
  s_add_u32 m0, s72, 82944
  v_lshlrev_b32 v18, 16, v129
  v_and_b32 v19, 0xffff0000, v129
  v_add_f32 v14, v14, v18
  ds_read_b64_tr_b16 v[66:67], v12 offset:25088
  ds_read_b64_tr_b16 v[68:69], v12 offset:32768
  buffer_load_dwordx4 v2, s[24:27], s65 offen lds
  v_mfma_f32_16x16x32_bf16 v[28:31], v[40:43], v[20:23], 0
  v_add_f32 v15, v15, v19
  v_fmac_f32 v16, v18, v18
  v_fmac_f32 v17, v19, v19
  ds_read_b64_tr_b16 v[70:71], v12 offset:33280
  ds_read_b128 v[140:143], v9
  v_mfma_f32_32x32x16_bf16 v[112:127], v[44:47], v[128:131], 0
  s_add_u32 m0, s73, 98304
  v_lshlrev_b32 v18, 16, v130
  v_and_b32 v19, 0xffff0000, v130
  v_add_f32 v14, v14, v18
  ds_read_b64_tr_b16 v[36:37], v13 offset:16384
  ds_read_b64_tr_b16 v[38:39], v13 offset:16896
  buffer_load_dwordx4 v3, s[28:31], s66 offen lds
  v_mfma_f32_16x16x32_bf16 v[32:35], v[44:47], v[20:23], 0
  v_add_f32 v15, v15, v19
  v_fmac_f32 v16, v18, v18
  v_fmac_f32 v17, v19, v19
  ds_read_b64_tr_b16 v[40:41], v13 offset:24576
  ds_read_b64_tr_b16 v[42:43], v13 offset:25088
  s_waitcnt lgkmcnt(12)
  v_mfma_f32_32x32x16_bf16 v[80:95], v[48:51], v[132:135], v[80:95]
  s_add_u32 m0, s73, 106496
  v_lshlrev_b32 v18, 16, v131
  v_and_b32 v19, 0xffff0000, v131
  v_add_f32 v14, v14, v18
  ds_read_b64_tr_b16 v[44:45], v13 offset:32768
  ds_read_b64_tr_b16 v[46:47], v13 offset:33280
  buffer_load_dwordx4 v4, s[32:35], s67 offen lds
  v_mfma_f32_32x32x16_bf16 v[96:111], v[52:55], v[132:135], v[96:111]
  v_add_f32 v15, v15, v19
  v_fmac_f32 v16, v18, v18
  v_fmac_f32 v17, v19, v19
  v_mfma_f32_32x32x16_bf16 v[112:127], v[56:59], v[132:135], v[112:127]
  s_add_u32 m0, s73, 114688
  s_nop 0
  buffer_load_dwordx4 v4, s[36:39], s67 offen lds
  s_waitcnt lgkmcnt(0)
  s_waitcnt vmcnt(5)
  s_barrier
  v_mfma_f32_32x32x16_bf16 v[80:95], v[60:63], v[136:139], v[80:95]
  s_add_u32 s65, s76, 384
  s_mov_b32 s66, 589824
  s_mul_i32 s67, s64, 3
  s_add_u32 m0, s72, 0
  v_add_u32 v6, 40960, v6
  v_add_u32 v10, 40960, v10
  v_add_u32 v7, 40960, v7
  v_add_u32 v11, 40960, v11
  v_add_u32 v8, 40960, v8
  v_add_u32 v12, 40960, v12
  ds_read_b128 v[144:147], v6
  ds_read_b64_tr_b16 v[48:49], v10 offset:16384
  ds_read_b64_tr_b16 v[50:51], v10 offset:16896
  buffer_load_dwordx4 v1, s[24:27], s65 offen lds
  v_mfma_f32_32x32x16_bf16 v[96:111], v[64:67], v[136:139], v[96:111]
  v_add_u32 v9, 40960, v9
  v_add_u32 v13, 40960, v13
  v_lshlrev_b32 v18, 16, v136
  v_and_b32 v19, 0xffff0000, v136
  v_add_f32 v14, v14, v18
  v_add_f32 v15, v15, v19
  ds_read_b64_tr_b16 v[52:53], v10 offset:24576
  ds_read_b64_tr_b16 v[54:55], v10 offset:25088
  ds_read_b64_tr_b16 v[56:57], v10 offset:32768
  v_mfma_f32_32x32x16_bf16 v[112:127], v[68:71], v[136:139], v[112:127]
  s_add_u32 m0, s72, 1024
  v_fmac_f32 v16, v18, v18
  v_fmac_f32 v17, v19, v19
  v_lshlrev_b32 v18, 16, v137
  v_and_b32 v19, 0xffff0000, v137
  v_add_f32 v14, v14, v18
  v_add_f32 v15, v15, v19
  ds_read_b64_tr_b16 v[58:59], v10 offset:33280
  ds_read_b128 v[148:151], v7
  ds_read_b64_tr_b16 v[60:61], v11 offset:16384
  buffer_load_dwordx4 v2, s[24:27], s65 offen lds
  v_mfma_f32_32x32x16_bf16 v[80:95], v[36:39], v[140:143], v[80:95]
  v_fmac_f32 v16, v18, v18
  v_fmac_f32 v17, v19, v19
  v_lshlrev_b32 v18, 16, v138
  v_and_b32 v19, 0xffff0000, v138
  v_add_f32 v14, v14, v18
  v_add_f32 v15, v15, v19
  ds_read_b64_tr_b16 v[62:63], v11 offset:16896
  ds_read_b64_tr_b16 v[64:65], v11 offset:24576
  ds_read_b64_tr_b16 v[66:67], v11 offset:25088
  v_mfma_f32_32x32x16_bf16 v[96:111], v[40:43], v[140:143], v[96:111]
  s_add_u32 m0, s73, 16384
  v_fmac_f32 v16, v18, v18
  v_fmac_f32 v17, v19, v19
  v_lshlrev_b32 v18, 16, v139
  v_and_b32 v19, 0xffff0000, v139
  v_add_f32 v14, v14, v18
  v_add_f32 v15, v15, v19
  ds_read_b64_tr_b16 v[68:69], v11 offset:32768
  ds_read_b64_tr_b16 v[70:71], v11 offset:33280
  buffer_load_dwordx4 v3, s[28:31], s66 offen lds
  v_mfma_f32_32x32x16_bf16 v[112:127], v[44:47], v[140:143], v[112:127]
  v_fmac_f32 v16, v18, v18
  v_fmac_f32 v17, v19, v19
  s_waitcnt lgkmcnt(7)
  v_mfma_f32_32x32x16_bf16 v[80:95], v[48:51], v[144:147], v[80:95]
  v_lshlrev_b32 v18, 16, v144
  v_and_b32 v19, 0xffff0000, v144
  v_add_f32 v14, v14, v18
  ds_read_b128 v[152:155], v8
  ds_read_b64_tr_b16 v[36:37], v12 offset:16384
  v_mfma_f32_16x16x32_bf16 v[24:27], v[48:51], v[20:23], v[24:27]
  s_add_u32 m0, s73, 24576
  v_add_f32 v15, v15, v19
  v_fmac_f32 v16, v18, v18
  v_fmac_f32 v17, v19, v19
  ds_read_b64_tr_b16 v[38:39], v12 offset:16896
  ds_read_b64_tr_b16 v[40:41], v12 offset:24576
  buffer_load_dwordx4 v4, s[32:35], s67 offen lds
  v_mfma_f32_32x32x16_bf16 v[96:111], v[52:55], v[144:147], v[96:111]
  v_lshlrev_b32 v18, 16, v145
  v_and_b32 v19, 0xffff0000, v145
  v_add_f32 v14, v14, v18
  ds_read_b64_tr_b16 v[42:43], v12 offset:25088
  ds_read_b64_tr_b16 v[44:45], v12 offset:32768
  v_mfma_f32_16x16x32_bf16 v[28:31], v[52:55], v[20:23], v[28:31]
  v_add_f32 v15, v15, v19
  v_fmac_f32 v16, v18, v18
  v_fmac_f32 v17, v19, v19
  ds_read_b64_tr_b16 v[46:47], v12 offset:33280
  ds_read_b128 v[156:159], v9
  v_mfma_f32_32x32x16_bf16 v[112:127], v[56:59], v[144:147], v[112:127]
  v_lshlrev_b32 v18, 16, v146
  v_and_b32 v19, 0xffff0000, v146
  v_add_f32 v14, v14, v18
  ds_read_b64_tr_b16 v[48:49], v13 offset:16384
  ds_read_b64_tr_b16 v[50:51], v13 offset:16896
  v_mfma_f32_16x16x32_bf16 v[32:35], v[56:59], v[20:23], v[32:35]
  s_add_u32 m0, s73, 32768
  v_add_f32 v15, v15, v19
  v_fmac_f32 v16, v18, v18
  v_fmac_f32 v17, v19, v19
  ds_read_b64_tr_b16 v[52:53], v13 offset:24576
  ds_read_b64_tr_b16 v[54:55], v13 offset:25088
  buffer_load_dwordx4 v4, s[36:39], s67 offen lds
  s_waitcnt lgkmcnt(12)
  v_mfma_f32_32x32x16_bf16 v[80:95], v[60:63], v[148:151], v[80:95]
  v_lshlrev_b32 v18, 16, v147
  v_and_b32 v19, 0xffff0000, v147
  v_add_f32 v14, v14, v18
  ds_read_b64_tr_b16 v[56:57], v13 offset:32768
  ds_read_b64_tr_b16 v[58:59], v13 offset:33280
  v_mfma_f32_32x32x16_bf16 v[96:111], v[64:67], v[148:151], v[96:111]
  v_add_f32 v15, v15, v19
  v_fmac_f32 v16, v18, v18
  v_fmac_f32 v17, v19, v19
  v_mfma_f32_32x32x16_bf16 v[112:127], v[68:71], v[148:151], v[112:127]
  s_waitcnt lgkmcnt(0)
  s_waitcnt vmcnt(5)
  s_barrier
  v_mfma_f32_32x32x16_bf16 v[80:95], v[36:39], v[152:155], v[80:95]
  s_add_u32 s65, s76, 512
  s_mov_b32 s66, 786432
  s_mul_i32 s67, s64, 4
  s_add_u32 m0, s72, 40960
  v_add_u32 v6, 40960, v6
  v_add_u32 v10, 40960, v10
  v_add_u32 v7, 40960, v7
  v_add_u32 v11, 40960, v11
  v_add_u32 v8, 40960, v8
  v_add_u32 v12, 40960, v12
  ds_read_b128 v[160:163], v6
  ds_read_b64_tr_b16 v[60:61], v10 offset:16384
  ds_read_b64_tr_b16 v[62:63], v10 offset:16896
  buffer_load_dwordx4 v1, s[24:27], s65 offen lds
  v_mfma_f32_32x32x16_bf16 v[96:111], v[40:43], v[152:155], v[96:111]
  v_add_u32 v9, 40960, v9
  v_add_u32 v13, 40960, v13
  v_lshlrev_b32 v18, 16, v152
  v_and_b32 v19, 0xffff0000, v152
  v_add_f32 v14, v14, v18
  v_add_f32 v15, v15, v19
  ds_read_b64_tr_b16 v[64:65], v10 offset:24576
  ds_read_b64_tr_b16 v[66:67], v10 offset:25088
  ds_read_b64_tr_b16 v[68:69], v10 offset:32768
  v_mfma_f32_32x32x16_bf16 v[112:127], v[44:47], v[152:155], v[112:127]
  s_add_u32 m0, s72, 41984
  v_fmac_f32 v16, v18, v18
  v_fmac_f32 v17, v19, v19
  v_lshlrev_b32 v18, 16, v153
  v_and_b32 v19, 0xffff0000, v153
  v_add_f32 v14, v14, v18
  v_add_f32 v15, v15, v19
  ds_read_b64_tr_b16 v[70:71], v10 offset:33280
  ds_read_b128 v[164:167], v7
  ds_read_b64_tr_b16 v[36:37], v11 offset:16384
  buffer_load_dwordx4 v2, s[24:27], s65 offen lds
  v_mfma_f32_32x32x16_bf16 v[80:95], v[48:51], v[156:159], v[80:95]
  v_fmac_f32 v16, v18, v18
  v_fmac_f32 v17, v19, v19
  v_lshlrev_b32 v18, 16, v154
  v_and_b32 v19, 0xffff0000, v154
  v_add_f32 v14, v14, v18
  v_add_f32 v15, v15, v19
  ds_read_b64_tr_b16 v[38:39], v11 offset:16896
  ds_read_b64_tr_b16 v[40:41], v11 offset:24576
  ds_read_b64_tr_b16 v[42:43], v11 offset:25088
  v_mfma_f32_32x32x16_bf16 v[96:111], v[52:55], v[156:159], v[96:111]
  s_add_u32 m0, s73, 57344
  v_fmac_f32 v16, v18, v18
  v_fmac_f32 v17, v19, v19
  v_lshlrev_b32 v18, 16, v155
  v_and_b32 v19, 0xffff0000, v155
  v_add_f32 v14, v14, v18
  v_add_f32 v15, v15, v19
  ds_read_b64_tr_b16 v[44:45], v11 offset:32768
  ds_read_b64_tr_b16 v[46:47], v11 offset:33280
  buffer_load_dwordx4 v3, s[28:31], s66 offen lds
  v_mfma_f32_32x32x16_bf16 v[112:127], v[56:59], v[156:159], v[112:127]
  v_fmac_f32 v16, v18, v18
  v_fmac_f32 v17, v19, v19
  s_lshl_b32 s97, s63, 3
  s_add_u32 s97, s97, s56
  s_mul_i32 s97, s97, 28672
  v_and_b32 v73, 7, v0
  v_mul_u32_u24 v73, 3584, v73
  s_mov_b32 m0, 161152
  s_mov_b64 exec, 0xff
  buffer_load_dword v73, s[40:43], s97 offen lds
  buffer_load_dword v73, s[44:47], s97 offen lds
  s_mov_b64 exec, -1
  s_waitcnt lgkmcnt(7)
  v_mfma_f32_32x32x16_bf16 v[80:95], v[60:63], v[160:163], v[80:95]
  v_lshlrev_b32 v18, 16, v160
  v_and_b32 v19, 0xffff0000, v160
  v_add_f32 v14, v14, v18
  ds_read_b128 v[168:171], v8
  ds_read_b64_tr_b16 v[48:49], v12 offset:16384
  v_mfma_f32_16x16x32_bf16 v[24:27], v[60:63], v[20:23], v[24:27]
  s_add_u32 m0, s73, 65536
  v_add_f32 v15, v15, v19
  v_fmac_f32 v16, v18, v18
  v_fmac_f32 v17, v19, v19
  ds_read_b64_tr_b16 v[50:51], v12 offset:16896
  ds_read_b64_tr_b16 v[52:53], v12 offset:24576
  buffer_load_dwordx4 v4, s[32:35], s67 offen lds
  v_mfma_f32_32x32x16_bf16 v[96:111], v[64:67], v[160:163], v[96:111]
  v_lshlrev_b32 v18, 16, v161
  v_and_b32 v19, 0xffff0000, v161
  v_add_f32 v14, v14, v18
  ds_read_b64_tr_b16 v[54:55], v12 offset:25088
  ds_read_b64_tr_b16 v[56:57], v12 offset:32768
  v_mfma_f32_16x16x32_bf16 v[28:31], v[64:67], v[20:23], v[28:31]
  v_add_f32 v15, v15, v19
  v_fmac_f32 v16, v18, v18
  v_fmac_f32 v17, v19, v19
  ds_read_b64_tr_b16 v[58:59], v12 offset:33280
  ds_read_b128 v[172:175], v9
  v_mfma_f32_32x32x16_bf16 v[112:127], v[68:71], v[160:163], v[112:127]
  v_lshlrev_b32 v18, 16, v162
  v_and_b32 v19, 0xffff0000, v162
  v_add_f32 v14, v14, v18
  ds_read_b64_tr_b16 v[60:61], v13 offset:16384
  ds_read_b64_tr_b16 v[62:63], v13 offset:16896
  v_mfma_f32_16x16x32_bf16 v[32:35], v[68:71], v[20:23], v[32:35]
  s_add_u32 m0, s73, 73728
  v_add_f32 v15, v15, v19
  v_fmac_f32 v16, v18, v18
  v_fmac_f32 v17, v19, v19
  ds_read_b64_tr_b16 v[64:65], v13 offset:24576
  ds_read_b64_tr_b16 v[66:67], v13 offset:25088
  buffer_load_dwordx4 v4, s[36:39], s67 offen lds
  s_waitcnt lgkmcnt(12)
  v_mfma_f32_32x32x16_bf16 v[80:95], v[36:39], v[164:167], v[80:95]
  v_lshlrev_b32 v18, 16, v163
  v_and_b32 v19, 0xffff0000, v163
  v_add_f32 v14, v14, v18
  ds_read_b64_tr_b16 v[68:69], v13 offset:32768
  ds_read_b64_tr_b16 v[70:71], v13 offset:33280
  v_mfma_f32_32x32x16_bf16 v[96:111], v[40:43], v[164:167], v[96:111]
  v_add_f32 v15, v15, v19
  v_fmac_f32 v16, v18, v18
  v_fmac_f32 v17, v19, v19
  v_mfma_f32_32x32x16_bf16 v[112:127], v[44:47], v[164:167], v[112:127]
  s_waitcnt lgkmcnt(0)
  s_waitcnt vmcnt(7)
  s_barrier
  v_mfma_f32_32x32x16_bf16 v[80:95], v[48:51], v[168:171], v[80:95]
  s_add_u32 s65, s76, 640
  s_mov_b32 s66, 983040
  s_mul_i32 s67, s64, 5
  s_add_u32 m0, s72, 81920
  v_add_u32 v6, 4294885376, v6
  v_add_u32 v10, 4294885376, v10
  v_add_u32 v7, 4294885376, v7
  v_add_u32 v11, 4294885376, v11
  v_add_u32 v8, 4294885376, v8
  v_add_u32 v12, 4294885376, v12
  ds_read_b128 v[176:179], v6
  ds_read_b64_tr_b16 v[36:37], v10 offset:16384
  ds_read_b64_tr_b16 v[38:39], v10 offset:16896
  buffer_load_dwordx4 v1, s[24:27], s65 offen lds
  v_mfma_f32_32x32x16_bf16 v[96:111], v[52:55], v[168:171], v[96:111]
  v_add_u32 v9, 4294885376, v9
  v_add_u32 v13, 4294885376, v13
  v_lshlrev_b32 v18, 16, v168
  v_and_b32 v19, 0xffff0000, v168
  v_add_f32 v14, v14, v18
  v_add_f32 v15, v15, v19
  ds_read_b64_tr_b16 v[40:41], v10 offset:24576
  ds_read_b64_tr_b16 v[42:43], v10 offset:25088
  ds_read_b64_tr_b16 v[44:45], v10 offset:32768
  v_mfma_f32_32x32x16_bf16 v[112:127], v[56:59], v[168:171], v[112:127]
  s_add_u32 m0, s72, 82944
  v_fmac_f32 v16, v18, v18
  v_fmac_f32 v17, v19, v19
  v_lshlrev_b32 v18, 16, v169
  v_and_b32 v19, 0xffff0000, v169
  v_add_f32 v14, v14, v18
  v_add_f32 v15, v15, v19
  ds_read_b64_tr_b16 v[46:47], v10 offset:33280
  ds_read_b128 v[180:183], v7
  ds_read_b64_tr_b16 v[48:49], v11 offset:16384
  buffer_load_dwordx4 v2, s[24:27], s65 offen lds
  v_mfma_f32_32x32x16_bf16 v[80:95], v[60:63], v[172:175], v[80:95]
  v_fmac_f32 v16, v18, v18
  v_fmac_f32 v17, v19, v19
  v_lshlrev_b32 v18, 16, v170
  v_and_b32 v19, 0xffff0000, v170
  v_add_f32 v14, v14, v18
  v_add_f32 v15, v15, v19
  ds_read_b64_tr_b16 v[50:51], v11 offset:16896
  ds_read_b64_tr_b16 v[52:53], v11 offset:24576
  ds_read_b64_tr_b16 v[54:55], v11 offset:25088
  v_mfma_f32_32x32x16_bf16 v[96:111], v[64:67], v[172:175], v[96:111]
  s_add_u32 m0, s73, 98304
  v_fmac_f32 v16, v18, v18
  v_fmac_f32 v17, v19, v19
  v_lshlrev_b32 v18, 16, v171
  v_and_b32 v19, 0xffff0000, v171
  v_add_f32 v14, v14, v18
  v_add_f32 v15, v15, v19
  ds_read_b64_tr_b16 v[56:57], v11 offset:32768
  ds_read_b64_tr_b16 v[58:59], v11 offset:33280
  buffer_load_dwordx4 v3, s[28:31], s66 offen lds
  v_mfma_f32_32x32x16_bf16 v[112:127], v[68:71], v[172:175], v[112:127]
  v_fmac_f32 v16, v18, v18
  v_fmac_f32 v17, v19, v19
  s_mov_b32 m0, 161152
  s_mov_b32 s99, 0
  s_mov_b64 exec, 15
  buffer_load_dword v74, s[20:23], s99 offen lds
  s_mov_b64 exec, -1
  s_waitcnt lgkmcnt(7)
  v_mfma_f32_32x32x16_bf16 v[80:95], v[36:39], v[176:179], v[80:95]
  v_lshlrev_b32 v18, 16, v176
  v_and_b32 v19, 0xffff0000, v176
  v_add_f32 v14, v14, v18
  ds_read_b128 v[184:187], v8
  ds_read_b64_tr_b16 v[60:61], v12 offset:16384
  v_mfma_f32_16x16x32_bf16 v[24:27], v[36:39], v[20:23], v[24:27]
  s_add_u32 m0, s73, 106496
  v_add_f32 v15, v15, v19
  v_fmac_f32 v16, v18, v18
  v_fmac_f32 v17, v19, v19
  ds_read_b64_tr_b16 v[62:63], v12 offset:16896
  ds_read_b64_tr_b16 v[64:65], v12 offset:24576
  buffer_load_dwordx4 v4, s[32:35], s67 offen lds
  v_mfma_f32_32x32x16_bf16 v[96:111], v[40:43], v[176:179], v[96:111]
  v_lshlrev_b32 v18, 16, v177
  v_and_b32 v19, 0xffff0000, v177
  v_add_f32 v14, v14, v18
  ds_read_b64_tr_b16 v[66:67], v12 offset:25088
  ds_read_b64_tr_b16 v[68:69], v12 offset:32768
  v_mfma_f32_16x16x32_bf16 v[28:31], v[40:43], v[20:23], v[28:31]
  v_add_f32 v15, v15, v19
  v_fmac_f32 v16, v18, v18
  v_fmac_f32 v17, v19, v19
  ds_read_b64_tr_b16 v[70:71], v12 offset:33280
  ds_read_b128 v[188:191], v9
  v_mfma_f32_32x32x16_bf16 v[112:127], v[44:47], v[176:179], v[112:127]
  v_lshlrev_b32 v18, 16, v178
  v_and_b32 v19, 0xffff0000, v178
  v_add_f32 v14, v14, v18
  ds_read_b64_tr_b16 v[36:37], v13 offset:16384
  ds_read_b64_tr_b16 v[38:39], v13 offset:16896
  v_mfma_f32_16x16x32_bf16 v[32:35], v[44:47], v[20:23], v[32:35]
  s_add_u32 m0, s73, 114688
  v_add_f32 v15, v15, v19
  v_fmac_f32 v16, v18, v18
  v_fmac_f32 v17, v19, v19
  ds_read_b64_tr_b16 v[40:41], v13 offset:24576
  ds_read_b64_tr_b16 v[42:43], v13 offset:25088
  buffer_load_dwordx4 v4, s[36:39], s67 offen lds
  s_waitcnt lgkmcnt(12)
  v_mfma_f32_32x32x16_bf16 v[80:95], v[48:51], v[180:183], v[80:95]
  v_lshlrev_b32 v18, 16, v179
  v_and_b32 v19, 0xffff0000, v179
  v_add_f32 v14, v14, v18
  ds_read_b64_tr_b16 v[44:45], v13 offset:32768
  ds_read_b64_tr_b16 v[46:47], v13 offset:33280
  v_mfma_f32_32x32x16_bf16 v[96:111], v[52:55], v[180:183], v[96:111]
  v_add_f32 v15, v15, v19
  v_fmac_f32 v16, v18, v18
  v_fmac_f32 v17, v19, v19
  v_mfma_f32_32x32x16_bf16 v[112:127], v[56:59], v[180:183], v[112:127]
  s_waitcnt lgkmcnt(0)
  s_waitcnt vmcnt(6)
  s_barrier
  buffer_load_dword v73, off, s[52:55], 0
  s_mov_b32 m0, 161152
  s_mov_b32 s99, 262144
  s_mov_b64 exec, 15
  buffer_load_dword v74, s[20:23], s99 offen lds
  s_mov_b64 exec, -1
  v_mfma_f32_32x32x16_bf16 v[80:95], v[60:63], v[184:187], v[80:95]
  s_add_u32 s65, s76, 768
  s_mov_b32 s66, 1179648
  s_mul_i32 s67, s64, 6
  s_add_u32 m0, s72, 0
  v_add_u32 v6, 40960, v6
  v_add_u32 v10, 40960, v10
  v_add_u32 v7, 40960, v7
  v_add_u32 v11, 40960, v11
  v_add_u32 v8, 40960, v8
  v_add_u32 v12, 40960, v12
  ds_read_b128 v[192:195], v6
  ds_read_b64_tr_b16 v[48:49], v10 offset:16384
  ds_read_b64_tr_b16 v[50:51], v10 offset:16896
  buffer_load_dwordx4 v1, s[24:27], s65 offen lds
  v_mfma_f32_32x32x16_bf16 v[96:111], v[64:67], v[184:187], v[96:111]
  v_add_u32 v9, 40960, v9
  v_add_u32 v13, 40960, v13
  v_lshlrev_b32 v18, 16, v184
  v_and_b32 v19, 0xffff0000, v184
  v_add_f32 v14, v14, v18
  v_add_f32 v15, v15, v19
  ds_read_b64_tr_b16 v[52:53], v10 offset:24576
  ds_read_b64_tr_b16 v[54:55], v10 offset:25088
  ds_read_b64_tr_b16 v[56:57], v10 offset:32768
  v_mfma_f32_32x32x16_bf16 v[112:127], v[68:71], v[184:187], v[112:127]
  s_add_u32 m0, s72, 1024
  v_fmac_f32 v16, v18, v18
  v_fmac_f32 v17, v19, v19
  v_lshlrev_b32 v18, 16, v185
  v_and_b32 v19, 0xffff0000, v185
  v_add_f32 v14, v14, v18
  v_add_f32 v15, v15, v19
  ds_read_b64_tr_b16 v[58:59], v10 offset:33280
  ds_read_b128 v[196:199], v7
  ds_read_b64_tr_b16 v[60:61], v11 offset:16384
  buffer_load_dwordx4 v2, s[24:27], s65 offen lds
  v_mfma_f32_32x32x16_bf16 v[80:95], v[36:39], v[188:191], v[80:95]
  v_fmac_f32 v16, v18, v18
  v_fmac_f32 v17, v19, v19
  v_lshlrev_b32 v18, 16, v186
  v_and_b32 v19, 0xffff0000, v186
  v_add_f32 v14, v14, v18
  v_add_f32 v15, v15, v19
  ds_read_b64_tr_b16 v[62:63], v11 offset:16896
  ds_read_b64_tr_b16 v[64:65], v11 offset:24576
  ds_read_b64_tr_b16 v[66:67], v11 offset:25088
  v_mfma_f32_32x32x16_bf16 v[96:111], v[40:43], v[188:191], v[96:111]
  s_add_u32 m0, s73, 16384
  v_fmac_f32 v16, v18, v18
  v_fmac_f32 v17, v19, v19
  v_lshlrev_b32 v18, 16, v187
  v_and_b32 v19, 0xffff0000, v187
  v_add_f32 v14, v14, v18
  v_add_f32 v15, v15, v19
  ds_read_b64_tr_b16 v[68:69], v11 offset:32768
  ds_read_b64_tr_b16 v[70:71], v11 offset:33280
  buffer_load_dwordx4 v3, s[28:31], s66 offen lds
  v_mfma_f32_32x32x16_bf16 v[112:127], v[44:47], v[188:191], v[112:127]
  v_fmac_f32 v16, v18, v18
  v_fmac_f32 v17, v19, v19
  s_mov_b32 s20, s16
  s_and_b32 s21, s17, 0xffff
  s_mov_b32 s22, 1835008
  s_mov_b32 m0, 161152
  s_mov_b32 s99, 0
  s_mov_b64 exec, 15
  buffer_load_dword v74, s[20:23], s99 offen lds
  s_mov_b64 exec, -1
  s_waitcnt lgkmcnt(7)
  v_mfma_f32_32x32x16_bf16 v[80:95], v[48:51], v[192:195], v[80:95]
  v_lshlrev_b32 v18, 16, v192
  v_and_b32 v19, 0xffff0000, v192
  v_add_f32 v14, v14, v18
  ds_read_b128 v[200:203], v8
  ds_read_b64_tr_b16 v[36:37], v12 offset:16384
  v_mfma_f32_16x16x32_bf16 v[24:27], v[48:51], v[20:23], v[24:27]
  s_add_u32 m0, s73, 24576
  v_add_f32 v15, v15, v19
  v_fmac_f32 v16, v18, v18
  v_fmac_f32 v17, v19, v19
  ds_read_b64_tr_b16 v[38:39], v12 offset:16896
  ds_read_b64_tr_b16 v[40:41], v12 offset:24576
  buffer_load_dwordx4 v4, s[32:35], s67 offen lds
  v_mfma_f32_32x32x16_bf16 v[96:111], v[52:55], v[192:195], v[96:111]
  v_lshlrev_b32 v18, 16, v193
  v_and_b32 v19, 0xffff0000, v193
  v_add_f32 v14, v14, v18
  ds_read_b64_tr_b16 v[42:43], v12 offset:25088
  ds_read_b64_tr_b16 v[44:45], v12 offset:32768
  v_mfma_f32_16x16x32_bf16 v[28:31], v[52:55], v[20:23], v[28:31]
  v_add_f32 v15, v15, v19
  v_fmac_f32 v16, v18, v18
  v_fmac_f32 v17, v19, v19
  ds_read_b64_tr_b16 v[46:47], v12 offset:33280
  ds_read_b128 v[204:207], v9
  v_mfma_f32_32x32x16_bf16 v[112:127], v[56:59], v[192:195], v[112:127]
  v_lshlrev_b32 v18, 16, v194
  v_and_b32 v19, 0xffff0000, v194
  v_add_f32 v14, v14, v18
  ds_read_b64_tr_b16 v[48:49], v13 offset:16384
  ds_read_b64_tr_b16 v[50:51], v13 offset:16896
  v_mfma_f32_16x16x32_bf16 v[32:35], v[56:59], v[20:23], v[32:35]
  s_add_u32 m0, s73, 32768
  v_add_f32 v15, v15, v19
  v_fmac_f32 v16, v18, v18
  v_fmac_f32 v17, v19, v19
  ds_read_b64_tr_b16 v[52:53], v13 offset:24576
  ds_read_b64_tr_b16 v[54:55], v13 offset:25088
  buffer_load_dwordx4 v4, s[36:39], s67 offen lds
  s_waitcnt lgkmcnt(12)
  v_mfma_f32_32x32x16_bf16 v[80:95], v[60:63], v[196:199], v[80:95]
  v_lshlrev_b32 v18, 16, v195
  v_and_b32 v19, 0xffff0000, v195
  v_add_f32 v14, v14, v18
  ds_read_b64_tr_b16 v[56:57], v13 offset:32768
  ds_read_b64_tr_b16 v[58:59], v13 offset:33280
  v_mfma_f32_32x32x16_bf16 v[96:111], v[64:67], v[196:199], v[96:111]
  v_add_f32 v15, v15, v19
  v_fmac_f32 v16, v18, v18
  v_fmac_f32 v17, v19, v19
  v_mfma_f32_32x32x16_bf16 v[112:127], v[68:71], v[196:199], v[112:127]
  s_waitcnt lgkmcnt(0)
  s_waitcnt vmcnt(8)
  s_barrier
  s_mov_b32 m0, 161152
  s_mov_b32 s99, 262144
  s_mov_b64 exec, 15
  buffer_load_dword v74, s[20:23], s99 offen lds
  s_mov_b64 exec, -1
  v_mfma_f32_32x32x16_bf16 v[80:95], v[36:39], v[200:203], v[80:95]
  s_add_u32 s65, s76, 896
  s_mov_b32 s66, 1376256
  s_mul_i32 s67, s64, 7
  s_add_u32 m0, s72, 40960
  v_add_u32 v6, 40960, v6
  v_add_u32 v10, 40960, v10
  v_add_u32 v7, 40960, v7
  v_add_u32 v11, 40960, v11
  v_add_u32 v8, 40960, v8
  v_add_u32 v12, 40960, v12
  ds_read_b128 v[208:211], v6
  ds_read_b64_tr_b16 v[60:61], v10 offset:16384
  ds_read_b64_tr_b16 v[62:63], v10 offset:16896
  buffer_load_dwordx4 v1, s[24:27], s65 offen lds
  v_mfma_f32_32x32x16_bf16 v[96:111], v[40:43], v[200:203], v[96:111]
  v_add_u32 v9, 40960, v9
  v_add_u32 v13, 40960, v13
  v_lshlrev_b32 v18, 16, v200
  v_and_b32 v19, 0xffff0000, v200
  v_add_f32 v14, v14, v18
  v_add_f32 v15, v15, v19
  ds_read_b64_tr_b16 v[64:65], v10 offset:24576
  ds_read_b64_tr_b16 v[66:67], v10 offset:25088
  ds_read_b64_tr_b16 v[68:69], v10 offset:32768
  v_mfma_f32_32x32x16_bf16 v[112:127], v[44:47], v[200:203], v[112:127]
  s_add_u32 m0, s72, 41984
  v_fmac_f32 v16, v18, v18
  v_fmac_f32 v17, v19, v19
  v_lshlrev_b32 v18, 16, v201
  v_and_b32 v19, 0xffff0000, v201
  v_add_f32 v14, v14, v18
  v_add_f32 v15, v15, v19
  ds_read_b64_tr_b16 v[70:71], v10 offset:33280
  ds_read_b128 v[212:215], v7
  ds_read_b64_tr_b16 v[36:37], v11 offset:16384
  buffer_load_dwordx4 v2, s[24:27], s65 offen lds
  v_mfma_f32_32x32x16_bf16 v[80:95], v[48:51], v[204:207], v[80:95]
  v_fmac_f32 v16, v18, v18
  v_fmac_f32 v17, v19, v19
  v_lshlrev_b32 v18, 16, v202
  v_and_b32 v19, 0xffff0000, v202
  v_add_f32 v14, v14, v18
  v_add_f32 v15, v15, v19
  ds_read_b64_tr_b16 v[38:39], v11 offset:16896
  ds_read_b64_tr_b16 v[40:41], v11 offset:24576
  ds_read_b64_tr_b16 v[42:43], v11 offset:25088
  v_mfma_f32_32x32x16_bf16 v[96:111], v[52:55], v[204:207], v[96:111]
  s_add_u32 m0, s73, 57344
  v_fmac_f32 v16, v18, v18
  v_fmac_f32 v17, v19, v19
  v_lshlrev_b32 v18, 16, v203
  v_and_b32 v19, 0xffff0000, v203
  v_add_f32 v14, v14, v18
  v_add_f32 v15, v15, v19
  ds_read_b64_tr_b16 v[44:45], v11 offset:32768
  ds_read_b64_tr_b16 v[46:47], v11 offset:33280
  buffer_load_dwordx4 v3, s[28:31], s66 offen lds
  v_mfma_f32_32x32x16_bf16 v[112:127], v[56:59], v[204:207], v[112:127]
  v_fmac_f32 v16, v18, v18
  v_fmac_f32 v17, v19, v19
  s_mov_b32 m0, 161152
  s_mov_b32 s99, 524288
  s_mov_b64 exec, 15
  buffer_load_dword v74, s[20:23], s99 offen lds
  s_mov_b64 exec, -1
  s_waitcnt lgkmcnt(7)
  v_mfma_f32_32x32x16_bf16 v[80:95], v[60:63], v[208:211], v[80:95]
  v_lshlrev_b32 v18, 16, v208
  v_and_b32 v19, 0xffff0000, v208
  v_add_f32 v14, v14, v18
  ds_read_b128 v[216:219], v8
  ds_read_b64_tr_b16 v[48:49], v12 offset:16384
  v_mfma_f32_16x16x32_bf16 v[24:27], v[60:63], v[20:23], v[24:27]
  s_add_u32 m0, s73, 65536
  v_add_f32 v15, v15, v19
  v_fmac_f32 v16, v18, v18
  v_fmac_f32 v17, v19, v19
  ds_read_b64_tr_b16 v[50:51], v12 offset:16896
  ds_read_b64_tr_b16 v[52:53], v12 offset:24576
  buffer_load_dwordx4 v4, s[32:35], s67 offen lds
  v_mfma_f32_32x32x16_bf16 v[96:111], v[64:67], v[208:211], v[96:111]
  v_lshlrev_b32 v18, 16, v209
  v_and_b32 v19, 0xffff0000, v209
  v_add_f32 v14, v14, v18
  ds_read_b64_tr_b16 v[54:55], v12 offset:25088
  ds_read_b64_tr_b16 v[56:57], v12 offset:32768
  v_mfma_f32_16x16x32_bf16 v[28:31], v[64:67], v[20:23], v[28:31]
  v_add_f32 v15, v15, v19
  v_fmac_f32 v16, v18, v18
  v_fmac_f32 v17, v19, v19
  ds_read_b64_tr_b16 v[58:59], v12 offset:33280
  ds_read_b128 v[220:223], v9
  v_mfma_f32_32x32x16_bf16 v[112:127], v[68:71], v[208:211], v[112:127]
  v_lshlrev_b32 v18, 16, v210
  v_and_b32 v19, 0xffff0000, v210
  v_add_f32 v14, v14, v18
  ds_read_b64_tr_b16 v[60:61], v13 offset:16384
  ds_read_b64_tr_b16 v[62:63], v13 offset:16896
  v_mfma_f32_16x16x32_bf16 v[32:35], v[68:71], v[20:23], v[32:35]
  s_add_u32 m0, s73, 73728
  v_add_f32 v15, v15, v19
  v_fmac_f32 v16, v18, v18
  v_fmac_f32 v17, v19, v19
  ds_read_b64_tr_b16 v[64:65], v13 offset:24576
  ds_read_b64_tr_b16 v[66:67], v13 offset:25088
  buffer_load_dwordx4 v4, s[36:39], s67 offen lds
  s_waitcnt lgkmcnt(12)
  v_mfma_f32_32x32x16_bf16 v[80:95], v[36:39], v[212:215], v[80:95]
  v_lshlrev_b32 v18, 16, v211
  v_and_b32 v19, 0xffff0000, v211
  v_add_f32 v14, v14, v18
  ds_read_b64_tr_b16 v[68:69], v13 offset:32768
  ds_read_b64_tr_b16 v[70:71], v13 offset:33280
  v_mfma_f32_32x32x16_bf16 v[96:111], v[40:43], v[212:215], v[96:111]
  v_add_f32 v15, v15, v19
  v_fmac_f32 v16, v18, v18
  v_fmac_f32 v17, v19, v19
  v_mfma_f32_32x32x16_bf16 v[112:127], v[44:47], v[212:215], v[112:127]
  s_waitcnt lgkmcnt(0)
  s_waitcnt vmcnt(7)
  s_barrier
  s_mov_b32 m0, 161152
  s_mov_b32 s99, 786432
  s_mov_b64 exec, 15
  buffer_load_dword v74, s[20:23], s99 offen lds
  s_mov_b64 exec, -1
  v_mfma_f32_32x32x16_bf16 v[80:95], v[48:51], v[216:219], v[80:95]
  s_mov_b32 s66, 0
  s_add_u32 m0, s73, 81920
  v_add_u32 v6, 4294885376, v6
  v_add_u32 v10, 4294885376, v10
  v_add_u32 v7, 4294885376, v7
  v_add_u32 v11, 4294885376, v11
  v_add_u32 v8, 4294885376, v8
  v_add_u32 v12, 4294885376, v12
  ds_read_b128 v[224:227], v6
  ds_read_b64_tr_b16 v[36:37], v10 offset:16384
  ds_read_b64_tr_b16 v[38:39], v10 offset:16896
  buffer_load_dwordx4 v5, s[40:43], s66 offen lds
  v_mfma_f32_32x32x16_bf16 v[96:111], v[52:55], v[216:219], v[96:111]
  v_add_u32 v9, 4294885376, v9
  v_add_u32 v13, 4294885376, v13
  v_lshlrev_b32 v18, 16, v216
  v_and_b32 v19, 0xffff0000, v216
  v_add_f32 v14, v14, v18
  v_add_f32 v15, v15, v19
  ds_read_b64_tr_b16 v[40:41], v10 offset:24576
  ds_read_b64_tr_b16 v[42:43], v10 offset:25088
  ds_read_b64_tr_b16 v[44:45], v10 offset:32768
  v_mfma_f32_32x32x16_bf16 v[112:127], v[56:59], v[216:219], v[112:127]
  s_add_u32 m0, s73, 90112
  v_fmac_f32 v16, v18, v18
  v_fmac_f32 v17, v19, v19
  v_lshlrev_b32 v18, 16, v217
  v_and_b32 v19, 0xffff0000, v217
  v_add_f32 v14, v14, v18
  v_add_f32 v15, v15, v19
  ds_read_b64_tr_b16 v[46:47], v10 offset:33280
  ds_read_b128 v[228:231], v7
  ds_read_b64_tr_b16 v[48:49], v11 offset:16384
  buffer_load_dwordx4 v5, s[44:47], s66 offen lds
  v_mfma_f32_32x32x16_bf16 v[80:95], v[60:63], v[220:223], v[80:95]
  v_fmac_f32 v16, v18, v18
  v_fmac_f32 v17, v19, v19
  v_lshlrev_b32 v18, 16, v218
  v_and_b32 v19, 0xffff0000, v218
  v_add_f32 v14, v14, v18
  v_add_f32 v15, v15, v19
  ds_read_b64_tr_b16 v[50:51], v11 offset:16896
  ds_read_b64_tr_b16 v[52:53], v11 offset:24576
  ds_read_b64_tr_b16 v[54:55], v11 offset:25088
  v_mfma_f32_32x32x16_bf16 v[96:111], v[64:67], v[220:223], v[96:111]
  s_mov_b32 s67, 229376
  s_add_u32 m0, s73, 98304
  v_fmac_f32 v16, v18, v18
  v_fmac_f32 v17, v19, v19
  v_lshlrev_b32 v18, 16, v219
  v_and_b32 v19, 0xffff0000, v219
  v_add_f32 v14, v14, v18
  v_add_f32 v15, v15, v19
  ds_read_b64_tr_b16 v[56:57], v11 offset:32768
  ds_read_b64_tr_b16 v[58:59], v11 offset:33280
  buffer_load_dwordx4 v5, s[40:43], s67 offen lds
  v_mfma_f32_32x32x16_bf16 v[112:127], v[68:71], v[220:223], v[112:127]
  v_fmac_f32 v16, v18, v18
  v_fmac_f32 v17, v19, v19
  s_waitcnt lgkmcnt(7)
  v_mfma_f32_32x32x16_bf16 v[80:95], v[36:39], v[224:227], v[80:95]
  v_lshlrev_b32 v18, 16, v224
  v_and_b32 v19, 0xffff0000, v224
  v_add_f32 v14, v14, v18
  ds_read_b128 v[232:235], v8
  ds_read_b64_tr_b16 v[60:61], v12 offset:16384
  v_mfma_f32_16x16x32_bf16 v[24:27], v[36:39], v[20:23], v[24:27]
  s_add_u32 m0, s73, 106496
  v_add_f32 v15, v15, v19
  v_fmac_f32 v16, v18, v18
  v_fmac_f32 v17, v19, v19
  ds_read_b64_tr_b16 v[62:63], v12 offset:16896
  ds_read_b64_tr_b16 v[64:65], v12 offset:24576
  buffer_load_dwordx4 v5, s[44:47], s67 offen lds
  v_mfma_f32_32x32x16_bf16 v[96:111], v[40:43], v[224:227], v[96:111]
  v_lshlrev_b32 v18, 16, v225
  v_and_b32 v19, 0xffff0000, v225
  v_add_f32 v14, v14, v18
  ds_read_b64_tr_b16 v[66:67], v12 offset:25088
  ds_read_b64_tr_b16 v[68:69], v12 offset:32768
  v_mfma_f32_16x16x32_bf16 v[28:31], v[40:43], v[20:23], v[28:31]
  v_add_f32 v15, v15, v19
  v_fmac_f32 v16, v18, v18
  v_fmac_f32 v17, v19, v19
  ds_read_b64_tr_b16 v[70:71], v12 offset:33280
  ds_read_b128 v[236:239], v9
  v_mfma_f32_32x32x16_bf16 v[112:127], v[44:47], v[224:227], v[112:127]
  v_lshlrev_b32 v18, 16, v226
  v_and_b32 v19, 0xffff0000, v226
  v_add_f32 v14, v14, v18
  ds_read_b64_tr_b16 v[36:37], v13 offset:16384
  ds_read_b64_tr_b16 v[38:39], v13 offset:16896
  v_mfma_f32_16x16x32_bf16 v[32:35], v[44:47], v[20:23], v[32:35]
  v_add_f32 v15, v15, v19
  v_fmac_f32 v16, v18, v18
  v_fmac_f32 v17, v19, v19
  ds_read_b64_tr_b16 v[40:41], v13 offset:24576
  ds_read_b64_tr_b16 v[42:43], v13 offset:25088
  s_waitcnt lgkmcnt(12)
  v_mfma_f32_32x32x16_bf16 v[80:95], v[48:51], v[228:231], v[80:95]
  v_lshlrev_b32 v18, 16, v227
  v_and_b32 v19, 0xffff0000, v227
  v_add_f32 v14, v14, v18
  ds_read_b64_tr_b16 v[44:45], v13 offset:32768
  ds_read_b64_tr_b16 v[46:47], v13 offset:33280
  v_mfma_f32_32x32x16_bf16 v[96:111], v[52:55], v[228:231], v[96:111]
  v_add_f32 v15, v15, v19
  v_fmac_f32 v16, v18, v18
  v_fmac_f32 v17, v19, v19
  v_mfma_f32_32x32x16_bf16 v[112:127], v[56:59], v[228:231], v[112:127]
  s_waitcnt lgkmcnt(0)
  s_waitcnt vmcnt(5)
  s_barrier
  s_mov_b32 m0, 161152
  s_mov_b32 s99, 1048576
  s_mov_b64 exec, 15
  buffer_load_dword v74, s[20:23], s99 offen lds
  s_mov_b64 exec, -1
  v_mfma_f32_32x32x16_bf16 v[80:95], v[60:63], v[232:235], v[80:95]
  s_mov_b32 s66, 458752
  s_add_u32 m0, s73, 0
  v_add_u32 v6, 40960, v6
  v_add_u32 v10, 40960, v10
  v_add_u32 v7, 40960, v7
  v_add_u32 v11, 40960, v11
  v_add_u32 v8, 40960, v8
  v_add_u32 v12, 40960, v12
  ds_read_b128 v[240:243], v6
  ds_read_b64_tr_b16 v[48:49], v10 offset:16384
  ds_read_b64_tr_b16 v[50:51], v10 offset:16896
  buffer_load_dwordx4 v5, s[40:43], s66 offen lds
  v_mfma_f32_32x32x16_bf16 v[96:111], v[64:67], v[232:235], v[96:111]
  v_add_u32 v9, 40960, v9
  v_add_u32 v13, 40960, v13
  v_lshlrev_b32 v18, 16, v232
  v_and_b32 v19, 0xffff0000, v232
  v_add_f32 v14, v14, v18
  v_add_f32 v15, v15, v19
  ds_read_b64_tr_b16 v[52:53], v10 offset:24576
  ds_read_b64_tr_b16 v[54:55], v10 offset:25088
  ds_read_b64_tr_b16 v[56:57], v10 offset:32768
  v_mfma_f32_32x32x16_bf16 v[112:127], v[68:71], v[232:235], v[112:127]
  s_add_u32 m0, s73, 8192
  v_fmac_f32 v16, v18, v18
  v_fmac_f32 v17, v19, v19
  v_lshlrev_b32 v18, 16, v233
  v_and_b32 v19, 0xffff0000, v233
  v_add_f32 v14, v14, v18
  v_add_f32 v15, v15, v19
  ds_read_b64_tr_b16 v[58:59], v10 offset:33280
  ds_read_b128 v[244:247], v7
  ds_read_b64_tr_b16 v[60:61], v11 offset:16384
  buffer_load_dwordx4 v5, s[44:47], s66 offen lds
  v_mfma_f32_32x32x16_bf16 v[80:95], v[36:39], v[236:239], v[80:95]
  v_fmac_f32 v16, v18, v18
  v_fmac_f32 v17, v19, v19
  v_lshlrev_b32 v18, 16, v234
  v_and_b32 v19, 0xffff0000, v234
  v_add_f32 v14, v14, v18
  v_add_f32 v15, v15, v19
  ds_read_b64_tr_b16 v[62:63], v11 offset:16896
  ds_read_b64_tr_b16 v[64:65], v11 offset:24576
  ds_read_b64_tr_b16 v[66:67], v11 offset:25088
  v_mfma_f32_32x32x16_bf16 v[96:111], v[40:43], v[236:239], v[96:111]
  s_mov_b32 s67, 688128
  s_add_u32 m0, s73, 16384
  v_fmac_f32 v16, v18, v18
  v_fmac_f32 v17, v19, v19
  v_lshlrev_b32 v18, 16, v235
  v_and_b32 v19, 0xffff0000, v235
  v_add_f32 v14, v14, v18
  v_add_f32 v15, v15, v19
  ds_read_b64_tr_b16 v[68:69], v11 offset:32768
  ds_read_b64_tr_b16 v[70:71], v11 offset:33280
  buffer_load_dwordx4 v5, s[40:43], s67 offen lds
  v_mfma_f32_32x32x16_bf16 v[112:127], v[44:47], v[236:239], v[112:127]
  v_fmac_f32 v16, v18, v18
  v_fmac_f32 v17, v19, v19
  s_waitcnt lgkmcnt(7)
  v_mfma_f32_32x32x16_bf16 v[80:95], v[48:51], v[240:243], v[80:95]
  v_lshlrev_b32 v18, 16, v240
  v_and_b32 v19, 0xffff0000, v240
  v_add_f32 v14, v14, v18
  v_add_f32 v15, v15, v19
  v_fmac_f32 v16, v18, v18
  v_fmac_f32 v17, v19, v19
  ds_read_b128 v[248:251], v8
  ds_read_b64_tr_b16 v[36:37], v12 offset:16384
  v_mfma_f32_16x16x32_bf16 v[24:27], v[48:51], v[20:23], v[24:27]
  s_add_u32 m0, s73, 24576
  v_lshlrev_b32 v18, 16, v241
  v_and_b32 v19, 0xffff0000, v241
  v_add_f32 v14, v14, v18
  v_add_f32 v15, v15, v19
  v_fmac_f32 v16, v18, v18
  v_fmac_f32 v17, v19, v19
  ds_read_b64_tr_b16 v[38:39], v12 offset:16896
  ds_read_b64_tr_b16 v[40:41], v12 offset:24576
  buffer_load_dwordx4 v5, s[44:47], s67 offen lds
  v_mfma_f32_32x32x16_bf16 v[96:111], v[52:55], v[240:243], v[96:111]
  v_lshlrev_b32 v18, 16, v242
  v_and_b32 v19, 0xffff0000, v242
  v_add_f32 v14, v14, v18
  v_add_f32 v15, v15, v19
  v_fmac_f32 v16, v18, v18
  v_fmac_f32 v17, v19, v19
  ds_read_b64_tr_b16 v[42:43], v12 offset:25088
  ds_read_b64_tr_b16 v[44:45], v12 offset:32768
  v_mfma_f32_16x16x32_bf16 v[28:31], v[52:55], v[20:23], v[28:31]
  v_lshlrev_b32 v18, 16, v243
  v_and_b32 v19, 0xffff0000, v243
  v_add_f32 v14, v14, v18
  v_add_f32 v15, v15, v19
  v_fmac_f32 v16, v18, v18
  v_fmac_f32 v17, v19, v19
  ds_read_b64_tr_b16 v[46:47], v12 offset:33280
  ds_read_b128 v[252:255], v9
  s_waitcnt lgkmcnt(7)
  v_mfma_f32_32x32x16_bf16 v[112:127], v[56:59], v[240:243], v[112:127]
  v_lshlrev_b32 v18, 16, v248
  v_and_b32 v19, 0xffff0000, v248
  v_add_f32 v14, v14, v18
  v_add_f32 v15, v15, v19
  v_fmac_f32 v16, v18, v18
  v_fmac_f32 v17, v19, v19
  ds_read_b64_tr_b16 v[48:49], v13 offset:16384
  ds_read_b64_tr_b16 v[50:51], v13 offset:16896
  v_mfma_f32_16x16x32_bf16 v[32:35], v[56:59], v[20:23], v[32:35]
  v_lshlrev_b32 v18, 16, v249
  v_and_b32 v19, 0xffff0000, v249
  v_add_f32 v14, v14, v18
  v_add_f32 v15, v15, v19
  v_fmac_f32 v16, v18, v18
  v_fmac_f32 v17, v19, v19
  ds_read_b64_tr_b16 v[52:53], v13 offset:24576
  ds_read_b64_tr_b16 v[54:55], v13 offset:25088
  v_mfma_f32_32x32x16_bf16 v[80:95], v[60:63], v[244:247], v[80:95]
  v_lshlrev_b32 v18, 16, v250
  v_and_b32 v19, 0xffff0000, v250
  v_add_f32 v14, v14, v18
  v_add_f32 v15, v15, v19
  v_fmac_f32 v16, v18, v18
  v_fmac_f32 v17, v19, v19
  ds_read_b64_tr_b16 v[56:57], v13 offset:32768
  ds_read_b64_tr_b16 v[58:59], v13 offset:33280
  v_mfma_f32_32x32x16_bf16 v[96:111], v[64:67], v[244:247], v[96:111]
  v_lshlrev_b32 v18, 16, v251
  v_and_b32 v19, 0xffff0000, v251
  v_add_f32 v14, v14, v18
  v_add_f32 v15, v15, v19
  v_fmac_f32 v16, v18, v18
  v_fmac_f32 v17, v19, v19
  v_mfma_f32_32x32x16_bf16 v[112:127], v[68:71], v[244:247], v[112:127]
  v_add_f32 v14, v14, v15
  v_add_f32 v16, v16, v17
  v_mov_b32 v15, v14
  v_mov_b32 v17, v16
  v_and_b32 v1, 31, v0
  v_lshlrev_b32 v1, 3, v1
  v_permlane32_swap_b32 v14, v15
  v_permlane32_swap_b32 v16, v17
  s_lshl_b32 s68, s56, 8
  s_add_u32 s68, s68, 135168
  v_add_u32 v1, s68, v1
  v_add_f32 v14, v14, v15
  v_add_f32 v15, v16, v17
  ds_write_b128 v76, v[24:27]
  ds_write_b128 v76, v[28:31] offset:128
  ds_write_b128 v76, v[32:35] offset:256
  ds_write_b64 v1, v[14:15]
  v_xor_b32 v1, 0x100, v1
  s_waitcnt lgkmcnt(0)
  s_waitcnt vmcnt(5)
  s_barrier
  v_mfma_f32_32x32x16_bf16 v[80:95], v[36:39], v[248:251], v[80:95]
  s_mov_b32 s66, 917504
  s_add_u32 m0, s73, 40960
  v_add_u32 v10, 40960, v10
  v_add_u32 v11, 40960, v11
  v_add_u32 v12, 40960, v12
  v_add_u32 v13, 40960, v13
  ds_read_b64 v[60:61], v77 offset:0
  ds_read_b64 v[62:63], v77 offset:384
  ds_read_b64 v[64:65], v77 offset:768
  ds_read_b64 v[66:67], v77 offset:1152
  ds_read_b64 v[16:17], v1
  buffer_load_dwordx4 v5, s[40:43], s66 offen lds
  v_mfma_f32_32x32x16_bf16 v[96:111], v[40:43], v[248:251], v[96:111]
  s_waitcnt lgkmcnt(0)
  v_add_f32 v60, v60, v62
  v_add_f32 v61, v61, v63
  v_add_f32 v64, v64, v66
  v_add_f32 v65, v65, v67
  v_add_f32 v60, v60, v64
  v_add_f32 v61, v61, v65
  v_mfma_f32_32x32x16_bf16 v[112:127], v[44:47], v[248:251], v[112:127]
  s_add_u32 m0, s73, 49152
  ds_write_b64 v78, v[60:61]
  v_add_f32 v14, v14, v16
  v_add_f32 v15, v15, v17
  v_mul_f32 v14, 0xbb000000, v14
  v_mul_f32 v17, v14, v14
  v_mov_b32 v19, 0x3b000000
  v_fma_f32 v16, v15, v19, -v17
  buffer_load_dwordx4 v5, s[44:47], s66 offen lds
  v_mfma_f32_32x32x16_bf16 v[80:95], v[48:51], v[252:255], v[80:95]
  s_mov_b32 s67, 1146880
  s_add_u32 m0, s73, 57344
  v_max_f32 v16, 0, v16
  v_add_f32 v16, 0x3727c5ac, v16
  v_rsq_f32 v15, v16
  s_nop 0
  v_mul_f32 v17, 0xc0135761, v15
  v_mul_f32 v18, v15, v15
  v_mul_f32 v18, v18, v15
  buffer_load_dwordx4 v5, s[40:43], s67 offen lds
  v_mfma_f32_32x32x16_bf16 v[96:111], v[52:55], v[252:255], v[96:111]
  v_mul_f32 v18, 0xbdd2d3e8, v18
  v_and_b32 v1, 31, v0
  v_lshrrev_b32 v2, 5, v0
  v_lshlrev_b32 v2, 4, v2
  v_lshl_add_u32 v1, v1, 5, v2
  s_lshl_b32 s68, s59, 12
  s_lshl_b32 s69, s57, 10
  v_mfma_f32_32x32x16_bf16 v[112:127], v[56:59], v[252:255], v[112:127]
  s_add_u32 m0, s73, 65536
  s_add_u32 s68, s68, s69
  v_add_u32 v1, s68, v1
  buffer_load_dwordx4 v5, s[44:47], s67 offen lds
X_end:
  v_readfirstlane_b32 s96, v73
  s_nop 0
  s_cmp_eq_u32 s96, 0
  s_cbranch_scc1 R2
B2:
  ds_read_b128 v[40:43], v79 offset:0
  ds_read_b128 v[44:47], v79 offset:32
  ds_read_b128 v[48:51], v79 offset:64
  ds_read_b128 v[52:55], v79 offset:96
  ds_read_b128 v[56:59], v79 offset:128
  ds_read_b128 v[60:63], v79 offset:160
  ds_read_b128 v[64:67], v79 offset:192
  ds_read_b128 v[68:71], v79 offset:224
  s_waitcnt lgkmcnt(4)
  v_fmac_f32 v80, v14, v40
  v_fmac_f32 v81, v14, v41
  v_fmac_f32 v82, v14, v42
  v_fmac_f32 v83, v14, v43
  v_fmac_f32 v84, v14, v44
  v_fmac_f32 v85, v14, v45
  v_fmac_f32 v86, v14, v46
  v_fmac_f32 v87, v14, v47
  v_fmac_f32 v88, v14, v48
  v_fmac_f32 v89, v14, v49
  v_fmac_f32 v90, v14, v50
  v_fmac_f32 v91, v14, v51
  v_fmac_f32 v92, v14, v52
  v_fmac_f32 v93, v14, v53
  v_fmac_f32 v94, v14, v54
  v_fmac_f32 v95, v14, v55
  ds_read_b128 v[40:43], v79 offset:256
  ds_read_b128 v[44:47], v79 offset:288
  ds_read_b128 v[48:51], v79 offset:320
  ds_read_b128 v[52:55], v79 offset:352
  s_waitcnt lgkmcnt(4)
  v_fmac_f32 v96, v14, v56
  v_fmac_f32 v97, v14, v57
  v_fmac_f32 v98, v14, v58
  v_fmac_f32 v99, v14, v59
  v_fmac_f32 v100, v14, v60
  v_fmac_f32 v101, v14, v61
  v_fmac_f32 v102, v14, v62
  v_fmac_f32 v103, v14, v63
  v_fmac_f32 v104, v14, v64
  v_fmac_f32 v105, v14, v65
  v_fmac_f32 v106, v14, v66
  v_fmac_f32 v107, v14, v67
  v_fmac_f32 v108, v14, v68
  v_fmac_f32 v109, v14, v69
  v_fmac_f32 v110, v14, v70
  v_fmac_f32 v111, v14, v71
  s_waitcnt lgkmcnt(0)
  v_fmac_f32 v112, v14, v40
  v_fmac_f32 v113, v14, v41
  v_fmac_f32 v114, v14, v42
  v_fmac_f32 v115, v14, v43
  v_fmac_f32 v116, v14, v44
  v_fmac_f32 v117, v14, v45
  v_fmac_f32 v118, v14, v46
  v_fmac_f32 v119, v14, v47
  v_fmac_f32 v120, v14, v48
  v_fmac_f32 v121, v14, v49
  v_fmac_f32 v122, v14, v50
  v_fmac_f32 v123, v14, v51
  v_fmac_f32 v124, v14, v52
  v_fmac_f32 v125, v14, v53
  v_fmac_f32 v126, v14, v54
  v_fmac_f32 v127, v14, v55
  s_add_u32 s97, s74, 0
  s_cmp_lt_u32 s97, 8
  s_cselect_b32 s77, 0x3eb8aa3b, 1.0
  s_lshl_b32 s97, s97, 2
  s_lshl_b32 s98, s58, 1
  s_add_u32 s97, s97, s98
  s_lshl_b32 s97, s97, 16
  s_add_u32 s97, s97, 9437184
  s_add_u32 s98, s97, 0x10000
  v_mul_f32 v48, s77, v15
  v_mul_f32 v80, v48, v80
  v_mul_f32 v81, v48, v81
  v_mul_f32 v82, v48, v82
  v_mul_f32 v83, v48, v83
  v_mul_f32 v84, v48, v84
  v_mul_f32 v85, v48, v85
  v_mul_f32 v86, v48, v86
  v_mul_f32 v87, v48, v87
  v_cvt_pk_bf16_f32 v40, v80, v81
  v_cvt_pk_bf16_f32 v41, v82, v83
  v_cvt_pk_bf16_f32 v42, v84, v85
  v_cvt_pk_bf16_f32 v43, v86, v87
  buffer_store_dwordx4 v[40:43], v1, s[48:51], s97 offen sc1
  v_mul_f32 v88, v48, v88
  v_mul_f32 v89, v48, v89
  v_mul_f32 v90, v48, v90
  v_mul_f32 v91, v48, v91
  v_mul_f32 v92, v48, v92
  v_mul_f32 v93, v48, v93
  v_mul_f32 v94, v48, v94
  v_mul_f32 v95, v48, v95
  v_cvt_pk_bf16_f32 v44, v88, v89
  v_cvt_pk_bf16_f32 v45, v90, v91
  v_cvt_pk_bf16_f32 v46, v92, v93
  v_cvt_pk_bf16_f32 v47, v94, v95
  buffer_store_dwordx4 v[44:47], v1, s[48:51], s98 offen sc1
  s_cmp_eq_u32 s62, 1
  s_cbranch_scc1 L_p1b
  ds_read_b64_tr_b16 v[36:37], v10 offset:0
  ds_read_b64_tr_b16 v[38:39], v10 offset:512
  ds_read_b64_tr_b16 v[76:77], v10 offset:8192
  ds_read_b64_tr_b16 v[78:79], v10 offset:8704
  ds_read_b64_tr_b16 v[6:7], v11 offset:0
  ds_read_b64_tr_b16 v[8:9], v11 offset:512
  ds_read_b64_tr_b16 v[32:33], v11 offset:8192
  ds_read_b64_tr_b16 v[34:35], v11 offset:8704
  s_waitcnt lgkmcnt(4)
  v_mfma_f32_32x32x16_bf16 v[40:55], v[36:39], v[128:131], 0
  s_lshl_b32 s79, s59, 4
  s_lshl_b32 s69, s60, 2
  s_add_u32 s69, s69, s61
  s_add_u32 s79, s79, s69
  s_lshr_b32 s82, s59, 1
  s_and_b32 s81, s79, 31
  s_lshl_b32 s84, s60, 3
  s_add_u32 s84, s84, s63
  v_mfma_f32_16x16x32_bf16 v[24:27], v[36:39], v[20:23], 0
  s_and_b32 s85, s2, 1
  s_lshl_b32 s85, s85, 2
  s_add_u32 s85, s85, s61
  s_and_b32 s86, s56, 3
  s_lshr_b32 s87, s56, 2
  s_lshl_b32 s83, s86, 1
  s_sub_u32 s83, 8, s83
  s_cmp_eq_u32 s82, 0
  s_cselect_b32 s83, s83, 0
  v_mfma_f32_32x32x16_bf16 v[56:71], v[76:79], v[128:131], 0
  v_and_b32 v2, 7, v0
  v_bfe_u32 v19, v0, 4, 1
  v_lshlrev_b32 v19, 2, v19
  v_xor_b32 v2, v2, v19
  v_mfma_f32_16x16x32_bf16 v[28:31], v[76:79], v[20:23], 0
  ds_read_b64_tr_b16 v[128:129], v12 offset:0
  ds_read_b64_tr_b16 v[130:131], v12 offset:512
  v_lshlrev_b32 v2, 4, v2
  v_lshrrev_b32 v19, 3, v0
  v_lshl_add_u32 v3, v19, 10, v2
  s_lshl_b32 s69, s85, 7
  s_lshl_b32 s70, s86, 14
  s_waitcnt lgkmcnt(2)
  v_mfma_f32_32x32x16_bf16 v[40:55], v[6:9], v[132:135], v[40:55]
  s_add_u32 s69, s69, s70
  v_add_u32 v3, s69, v3
  v_add_u32 v2, 7168, v3
  s_mov_b32 s28, s16
  s_and_b32 s29, s17, 0xffff
  s_mov_b32 s30, 1835008
  v_mfma_f32_32x32x16_bf16 v[56:71], v[32:35], v[132:135], v[56:71]
  ds_read_b64_tr_b16 v[132:133], v12 offset:8192
  ds_read_b64_tr_b16 v[134:135], v12 offset:8704
  ds_read_b64_tr_b16 v[36:37], v13 offset:0
  ds_read_b64_tr_b16 v[38:39], v13 offset:512
  ds_read_b64_tr_b16 v[76:77], v13 offset:8192
  ds_read_b64_tr_b16 v[78:79], v13 offset:8704
  s_mov_b32 s32, s8
  s_and_b32 s33, s9, 0xffff
  s_mov_b32 s34, 524288
  s_mov_b32 s36, s18
  s_and_b32 s37, s19, 0xffff
  s_mov_b32 s38, 2097152
  s_lshl_b32 s88, s84, 11
  s_lshl_b32 s69, s86, 16
  s_waitcnt lgkmcnt(4)
  v_mfma_f32_32x32x16_bf16 v[40:55], v[128:131], v[136:139], v[40:55]
  ds_read_b64_tr_b16 v[6:7], v10 offset:16384
  ds_read_b64_tr_b16 v[8:9], v10 offset:16896
  s_add_u32 s88, s88, s69
  s_lshl_b32 s69, s61, 1
  s_add_u32 s89, s63, s69
  s_and_b32 s89, s89, 0
  s_sub_u32 s69, s89, 6
  s_min_u32 s63, s89, s69
  s_lshl_b32 s90, s86, 11
  v_mfma_f32_32x32x16_bf16 v[56:71], v[132:135], v[136:139], v[56:71]
  ds_read_b64_tr_b16 v[32:33], v10 offset:24576
  ds_read_b64_tr_b16 v[34:35], v10 offset:25088
  s_waitcnt lgkmcnt(4)
  v_mfma_f32_32x32x16_bf16 v[40:55], v[36:39], v[140:143], v[40:55]
  ds_read_b64_tr_b16 v[128:129], v11 offset:16384
  ds_read_b64_tr_b16 v[130:131], v11 offset:16896
  v_mfma_f32_32x32x16_bf16 v[56:71], v[76:79], v[140:143], v[56:71]
  ds_read_b64_tr_b16 v[132:133], v11 offset:24576
  ds_read_b64_tr_b16 v[134:135], v11 offset:25088
  s_waitcnt lgkmcnt(4)
  v_mfma_f32_32x32x16_bf16 v[40:55], v[6:9], v[144:147], v[40:55]
  ds_read_b64_tr_b16 v[36:37], v12 offset:16384
  ds_read_b64_tr_b16 v[38:39], v12 offset:16896
  v_mfma_f32_16x16x32_bf16 v[24:27], v[6:9], v[20:23], v[24:27]
  ds_read_b64_tr_b16 v[76:77], v12 offset:24576
  ds_read_b64_tr_b16 v[78:79], v12 offset:25088
  v_mfma_f32_32x32x16_bf16 v[56:71], v[32:35], v[144:147], v[56:71]
  v_mfma_f32_16x16x32_bf16 v[28:31], v[32:35], v[20:23], v[28:31]
  s_waitcnt lgkmcnt(4)
  v_mfma_f32_32x32x16_bf16 v[40:55], v[128:131], v[148:151], v[40:55]
  ds_read_b64_tr_b16 v[6:7], v13 offset:16384
  ds_read_b64_tr_b16 v[8:9], v13 offset:16896
  s_lshl_b32 s97, s78, 1
  s_add_u32 s97, s97, s58
  s_lshl_b32 s97, s97, 7
  s_lshl_b32 s98, s59, 2
  s_add_u32 s97, s97, s98
  s_add_u32 s97, s97, s57
  s_lshl_b32 s97, s97, 10
  s_add_u32 s98, s97, 0x10000
  v_mul_f32 v144, v96, v96
  v_mfma_f32_32x32x16_bf16 v[56:71], v[132:135], v[148:151], v[56:71]
  ds_read_b64_tr_b16 v[32:33], v13 offset:24576
  ds_read_b64_tr_b16 v[34:35], v13 offset:25088
  v_mul_f32 v145, v97, v97
  v_mul_f32 v146, v98, v98
  v_mul_f32 v147, v99, v99
  v_fma_f32 v144, v144, v18, v17
  v_fma_f32 v145, v145, v18, v17
  s_waitcnt lgkmcnt(0)
  s_waitcnt vmcnt(6)
  s_barrier
  s_mov_b32 m0, 161152
  s_mov_b32 s99, 1310720
  s_mov_b64 exec, 15
  buffer_load_dword v74, s[20:23], s99 offen lds
  s_mov_b64 exec, -1
  v_mfma_f32_32x32x16_bf16 v[40:55], v[36:39], v[152:155], v[40:55]
  v_add_u32 v10, 4294885376, v10
  v_add_u32 v11, 4294885376, v11
  v_add_u32 v12, 4294885376, v12
  v_add_u32 v13, 4294885376, v13
  ds_read_b64_tr_b16 v[128:129], v10 offset:0
  ds_read_b64_tr_b16 v[130:131], v10 offset:512
  v_fma_f32 v146, v146, v18, v17
  v_fma_f32 v147, v147, v18, v17
  v_mul_f32 v144, v144, v96
  v_mul_f32 v145, v145, v97
  v_mul_f32 v146, v146, v98
  v_mfma_f32_32x32x16_bf16 v[56:71], v[76:79], v[152:155], v[56:71]
  s_mov_b32 s66, 1376256
  s_add_u32 m0, s73, 81920
  ds_read_b64_tr_b16 v[132:133], v10 offset:8192
  ds_read_b64_tr_b16 v[134:135], v10 offset:8704
  v_mul_f32 v147, v147, v99
  v_exp_f32 v144, v144
  v_exp_f32 v145, v145
  buffer_load_dwordx4 v5, s[40:43], s66 offen lds
  v_mfma_f32_32x32x16_bf16 v[40:55], v[6:9], v[156:159], v[40:55]
  ds_read_b64_tr_b16 v[36:37], v11 offset:0
  ds_read_b64_tr_b16 v[38:39], v11 offset:512
  v_exp_f32 v146, v146
  v_exp_f32 v147, v147
  v_mul_f32 v96, v96, v112
  v_mfma_f32_32x32x16_bf16 v[56:71], v[32:35], v[156:159], v[56:71]
  s_add_u32 m0, s73, 90112
  ds_read_b64_tr_b16 v[76:77], v11 offset:8192
  ds_read_b64_tr_b16 v[78:79], v11 offset:8704
  v_mul_f32 v97, v97, v113
  v_mul_f32 v98, v98, v114
  v_mul_f32 v99, v99, v115
  v_fma_f32 v144, v144, v16, v16
  v_fma_f32 v145, v145, v16, v16
  buffer_load_dwordx4 v5, s[44:47], s66 offen lds
  s_waitcnt lgkmcnt(4)
  v_mfma_f32_32x32x16_bf16 v[40:55], v[128:131], v[160:163], v[40:55]
  ds_read_b64_tr_b16 v[6:7], v12 offset:0
  ds_read_b64_tr_b16 v[8:9], v12 offset:512
  v_fma_f32 v146, v146, v16, v16
  v_fma_f32 v147, v147, v16, v16
  v_rcp_f32 v144, v144
  v_rcp_f32 v145, v145
  v_mfma_f32_16x16x32_bf16 v[24:27], v[128:131], v[20:23], v[24:27]
  s_mov_b32 s67, 1605632
  s_add_u32 m0, s73, 98304
  ds_read_b64_tr_b16 v[32:33], v12 offset:8192
  ds_read_b64_tr_b16 v[34:35], v12 offset:8704
  v_rcp_f32 v146, v146
  v_rcp_f32 v147, v147
  v_mul_f32 v96, v96, v144
  buffer_load_dwordx4 v5, s[40:43], s67 offen lds
  v_mfma_f32_32x32x16_bf16 v[56:71], v[132:135], v[160:163], v[56:71]
  v_mul_f32 v97, v97, v145
  v_mul_f32 v98, v98, v146
  v_mul_f32 v99, v99, v147
  v_cvt_pk_bf16_f32 v136, v96, v97
  v_cvt_pk_bf16_f32 v137, v98, v99
  v_mfma_f32_16x16x32_bf16 v[28:31], v[132:135], v[20:23], v[28:31]
  v_mul_f32 v144, v100, v100
  v_mul_f32 v145, v101, v101
  v_mul_f32 v146, v102, v102
  v_mul_f32 v147, v103, v103
  v_fma_f32 v144, v144, v18, v17
  s_waitcnt lgkmcnt(4)
  v_mfma_f32_32x32x16_bf16 v[40:55], v[36:39], v[164:167], v[40:55]
  ds_read_b64_tr_b16 v[128:129], v13 offset:0
  ds_read_b64_tr_b16 v[130:131], v13 offset:512
  v_fma_f32 v145, v145, v18, v17
  v_fma_f32 v146, v146, v18, v17
  v_fma_f32 v147, v147, v18, v17
  v_mul_f32 v144, v144, v100
  v_mul_f32 v145, v145, v101
  v_mfma_f32_32x32x16_bf16 v[56:71], v[76:79], v[164:167], v[56:71]
  s_add_u32 m0, s73, 106496
  ds_read_b64_tr_b16 v[132:133], v13 offset:8192
  ds_read_b64_tr_b16 v[134:135], v13 offset:8704
  v_mul_f32 v146, v146, v102
  v_mul_f32 v147, v147, v103
  v_exp_f32 v144, v144
  v_exp_f32 v145, v145
  buffer_load_dwordx4 v5, s[44:47], s67 offen lds
  s_waitcnt lgkmcnt(4)
  v_mfma_f32_32x32x16_bf16 v[40:55], v[6:9], v[168:171], v[40:55]
  ds_read_b64_tr_b16 v[36:37], v10 offset:16384
  ds_read_b64_tr_b16 v[38:39], v10 offset:16896
  v_exp_f32 v146, v146
  v_exp_f32 v147, v147
  v_mul_f32 v100, v100, v116
  v_mfma_f32_32x32x16_bf16 v[56:71], v[32:35], v[168:171], v[56:71]
  ds_read_b64_tr_b16 v[76:77], v10 offset:24576
  ds_read_b64_tr_b16 v[78:79], v10 offset:25088
  v_mul_f32 v101, v101, v117
  v_mul_f32 v102, v102, v118
  v_mul_f32 v103, v103, v119
  v_fma_f32 v144, v144, v16, v16
  v_fma_f32 v145, v145, v16, v16
  s_waitcnt lgkmcnt(4)
  v_mfma_f32_32x32x16_bf16 v[40:55], v[128:131], v[172:175], v[40:55]
  ds_read_b64_tr_b16 v[6:7], v11 offset:16384
  ds_read_b64_tr_b16 v[8:9], v11 offset:16896
  v_fma_f32 v146, v146, v16, v16
  v_fma_f32 v147, v147, v16, v16
  v_rcp_f32 v144, v144
  v_rcp_f32 v145, v145
  v_mfma_f32_32x32x16_bf16 v[56:71], v[132:135], v[172:175], v[56:71]
  ds_read_b64_tr_b16 v[32:33], v11 offset:24576
  ds_read_b64_tr_b16 v[34:35], v11 offset:25088
  v_rcp_f32 v146, v146
  v_rcp_f32 v147, v147
  v_mul_f32 v100, v100, v144
  s_waitcnt lgkmcnt(4)
  v_mfma_f32_32x32x16_bf16 v[40:55], v[36:39], v[176:179], v[40:55]
  ds_read_b64_tr_b16 v[128:129], v12 offset:16384
  ds_read_b64_tr_b16 v[130:131], v12 offset:16896
  v_mul_f32 v101, v101, v145
  v_mul_f32 v102, v102, v146
  v_mul_f32 v103, v103, v147
  v_cvt_pk_bf16_f32 v138, v100, v101
  v_cvt_pk_bf16_f32 v139, v102, v103
  v_mfma_f32_16x16x32_bf16 v[24:27], v[36:39], v[20:23], v[24:27]
  ds_read_b64_tr_b16 v[132:133], v12 offset:24576
  ds_read_b64_tr_b16 v[134:135], v12 offset:25088
  buffer_store_dwordx4 v[136:139], v72, s[48:51], s97 offen sc1
  v_mul_f32 v144, v104, v104
  v_mul_f32 v145, v105, v105
  v_mul_f32 v146, v106, v106
  v_mul_f32 v147, v107, v107
  v_mfma_f32_32x32x16_bf16 v[56:71], v[76:79], v[176:179], v[56:71]
  v_fma_f32 v144, v144, v18, v17
  v_fma_f32 v145, v145, v18, v17
  v_fma_f32 v146, v146, v18, v17
  v_fma_f32 v147, v147, v18, v17
  v_mul_f32 v144, v144, v104
  v_mfma_f32_16x16x32_bf16 v[28:31], v[76:79], v[20:23], v[28:31]
  v_mul_f32 v145, v145, v105
  v_mul_f32 v146, v146, v106
  v_mul_f32 v147, v147, v107
  v_exp_f32 v144, v144
  s_waitcnt lgkmcnt(4)
  v_mfma_f32_32x32x16_bf16 v[40:55], v[6:9], v[180:183], v[40:55]
  ds_read_b64_tr_b16 v[36:37], v13 offset:16384
  ds_read_b64_tr_b16 v[38:39], v13 offset:16896
  v_exp_f32 v145, v145
  v_exp_f32 v146, v146
  v_exp_f32 v147, v147
  v_mfma_f32_32x32x16_bf16 v[56:71], v[32:35], v[180:183], v[56:71]
  ds_read_b64_tr_b16 v[76:77], v13 offset:24576
  ds_read_b64_tr_b16 v[78:79], v13 offset:25088
  v_mul_f32 v104, v104, v120
  v_mul_f32 v105, v105, v121
  v_mul_f32 v106, v106, v122
  v_mul_f32 v107, v107, v123
  v_fma_f32 v144, v144, v16, v16
  s_waitcnt lgkmcnt(0)
  s_waitcnt vmcnt(6)
  s_barrier
  s_mov_b32 m0, 161152
  s_mov_b32 s99, 1572864
  s_mov_b64 exec, 15
  buffer_load_dword v74, s[20:23], s99 offen lds
  s_mov_b64 exec, -1
  s_cmp_eq_u32 s56, 0
  s_cbranch_scc1 R3
B3:
  v_mfma_f32_32x32x16_bf16 v[40:55], v[128:131], v[184:187], v[40:55]
  v_add_u32 v10, 40960, v10
  v_add_u32 v11, 40960, v11
  v_add_u32 v12, 40960, v12
  v_add_u32 v13, 40960, v13
  ds_read_b64_tr_b16 v[6:7], v10 offset:0
  ds_read_b64_tr_b16 v[8:9], v10 offset:512
  v_fma_f32 v145, v145, v16, v16
  v_fma_f32 v146, v146, v16, v16
  v_fma_f32 v147, v147, v16, v16
  v_rcp_f32 v144, v144
  v_mfma_f32_32x32x16_bf16 v[56:71], v[132:135], v[184:187], v[56:71]
  s_add_u32 m0, s72, 0
  s_lshl_b32 s68, s87, 18
  s_add_u32 s68, s68, 0
  ds_read_b64_tr_b16 v[32:33], v10 offset:8192
  ds_read_b64_tr_b16 v[34:35], v10 offset:8704
  v_rcp_f32 v145, v145
  v_rcp_f32 v146, v146
  v_rcp_f32 v147, v147
  buffer_load_dwordx4 v3, s[32:35], s68 offen lds
  v_mfma_f32_32x32x16_bf16 v[40:55], v[36:39], v[188:191], v[40:55]
  ds_read_b64_tr_b16 v[128:129], v11 offset:0
  ds_read_b64_tr_b16 v[130:131], v11 offset:512
  v_mul_f32 v104, v104, v144
  v_mul_f32 v105, v105, v145
  v_mul_f32 v106, v106, v146
  v_mul_f32 v107, v107, v147
  v_cvt_pk_bf16_f32 v140, v104, v105
  v_mfma_f32_32x32x16_bf16 v[56:71], v[76:79], v[188:191], v[56:71]
  ds_read_b64_tr_b16 v[132:133], v11 offset:8192
  ds_read_b64_tr_b16 v[134:135], v11 offset:8704
  v_cvt_pk_bf16_f32 v141, v106, v107
  v_mul_f32 v144, v108, v108
  v_mul_f32 v145, v109, v109
  v_mul_f32 v146, v110, v110
  v_mul_f32 v147, v111, v111
  buffer_load_dwordx4 v2, s[32:35], s68 offen offset:1024 lds
  s_waitcnt lgkmcnt(4)
  v_mfma_f32_32x32x16_bf16 v[40:55], v[6:9], v[192:195], v[40:55]
  ds_read_b64_tr_b16 v[36:37], v12 offset:0
  ds_read_b64_tr_b16 v[38:39], v12 offset:512
  v_fma_f32 v144, v144, v18, v17
  v_fma_f32 v145, v145, v18, v17
  v_fma_f32 v146, v146, v18, v17
  v_fma_f32 v147, v147, v18, v17
  v_mul_f32 v144, v144, v108
  v_mfma_f32_16x16x32_bf16 v[24:27], v[6:9], v[20:23], v[24:27]
  s_add_u32 m0, s72, 16384
  s_lshl_b32 s68, s87, 18
  s_add_u32 s68, s68, 65536
  ds_read_b64_tr_b16 v[76:77], v12 offset:8192
  ds_read_b64_tr_b16 v[78:79], v12 offset:8704
  v_mul_f32 v145, v145, v109
  v_mul_f32 v146, v146, v110
  v_mul_f32 v147, v147, v111
  v_exp_f32 v144, v144
  buffer_load_dwordx4 v3, s[32:35], s68 offen lds
  v_mfma_f32_32x32x16_bf16 v[56:71], v[32:35], v[192:195], v[56:71]
  v_exp_f32 v145, v145
  v_exp_f32 v146, v146
  v_exp_f32 v147, v147
  v_mfma_f32_16x16x32_bf16 v[28:31], v[32:35], v[20:23], v[28:31]
  v_mul_f32 v108, v108, v124
  v_mul_f32 v109, v109, v125
  v_mul_f32 v110, v110, v126
  v_mul_f32 v111, v111, v127
  v_fma_f32 v144, v144, v16, v16
  s_waitcnt lgkmcnt(4)
  v_mfma_f32_32x32x16_bf16 v[40:55], v[128:131], v[196:199], v[40:55]
  ds_read_b64_tr_b16 v[6:7], v13 offset:0
  ds_read_b64_tr_b16 v[8:9], v13 offset:512
  v_fma_f32 v145, v145, v16, v16
  v_fma_f32 v146, v146, v16, v16
  v_fma_f32 v147, v147, v16, v16
  v_rcp_f32 v144, v144
  v_mfma_f32_32x32x16_bf16 v[56:71], v[132:135], v[196:199], v[56:71]
  ds_read_b64_tr_b16 v[32:33], v13 offset:8192
  ds_read_b64_tr_b16 v[34:35], v13 offset:8704
  v_rcp_f32 v145, v145
  v_rcp_f32 v146, v146
  v_rcp_f32 v147, v147
  buffer_load_dwordx4 v2, s[32:35], s68 offen offset:1024 lds
  s_waitcnt lgkmcnt(4)
  v_mfma_f32_32x32x16_bf16 v[40:55], v[36:39], v[200:203], v[40:55]
  ds_read_b64_tr_b16 v[128:129], v10 offset:16384
  ds_read_b64_tr_b16 v[130:131], v10 offset:16896
  v_mul_f32 v108, v108, v144
  v_mul_f32 v109, v109, v145
  v_mul_f32 v110, v110, v146
  v_mul_f32 v111, v111, v147
  v_cvt_pk_bf16_f32 v142, v108, v109
  v_mfma_f32_32x32x16_bf16 v[56:71], v[76:79], v[200:203], v[56:71]
  ds_read_b64_tr_b16 v[132:133], v10 offset:24576
  ds_read_b64_tr_b16 v[134:135], v10 offset:25088
  v_cvt_pk_bf16_f32 v143, v110, v111
  buffer_store_dwordx4 v[140:143], v72, s[48:51], s98 offen sc1
  v_lshrrev_b32 v172, 4, v0
  v_lshlrev_b32 v172, 4, v172
  v_and_b32 v173, 1, v0
  s_waitcnt lgkmcnt(4)
  v_mfma_f32_32x32x16_bf16 v[40:55], v[6:9], v[204:207], v[40:55]
  ds_read_b64_tr_b16 v[36:37], v11 offset:16384
  ds_read_b64_tr_b16 v[38:39], v11 offset:16896
  v_lshl_add_u32 v172, v173, 6, v172
  s_lshl_b32 s69, s58, 2
  s_add_u32 s69, s69, s57
  s_mul_i32 s69, s69, 384
  s_add_u32 s69, s69, 122880
  v_add_u32 v172, s69, v172
  v_min_u32 v173, 47, v0
  v_mfma_f32_32x32x16_bf16 v[56:71], v[32:35], v[204:207], v[56:71]
  ds_read_b64_tr_b16 v[76:77], v11 offset:24576
  ds_read_b64_tr_b16 v[78:79], v11 offset:25088
  v_lshlrev_b32 v173, 3, v173
  s_mul_i32 s69, s58, 384
  s_add_u32 s69, s69, 125952
  v_add_u32 v174, s69, v173
  s_mul_i32 s70, s58, 1536
  s_add_u32 s70, s70, 122880
  v_add_u32 v173, s70, v173
  s_waitcnt lgkmcnt(4)
  v_mfma_f32_32x32x16_bf16 v[40:55], v[128:131], v[208:211], v[40:55]
  ds_read_b64_tr_b16 v[6:7], v12 offset:16384
  ds_read_b64_tr_b16 v[8:9], v12 offset:16896
  v_lshrrev_b32 v167, 5, v0
  v_lshlrev_b32 v167, 4, v167
  v_add_u32 v167, s69, v167
  v_and_b32 v190, 31, v0
  v_lshrrev_b32 v191, 5, v0
  v_mfma_f32_16x16x32_bf16 v[24:27], v[128:131], v[20:23], v[24:27]
  ds_read_b64_tr_b16 v[32:33], v12 offset:24576
  ds_read_b64_tr_b16 v[34:35], v12 offset:25088
  v_lshlrev_b32 v175, 2, v191
  v_sub_u32 v175, v190, v175
  v_cmp_le_i32 s[4:5], 0, v175
  v_cmp_le_i32 s[6:7], 1, v175
  v_cmp_le_i32 s[8:9], 2, v175
  v_mfma_f32_32x32x16_bf16 v[56:71], v[132:135], v[208:211], v[56:71]
  v_cmp_le_i32 s[10:11], 3, v175
  v_cmp_le_i32 s[12:13], 8, v175
  v_cmp_le_i32 s[14:15], 9, v175
  v_cmp_le_i32 s[16:17], 10, v175
  v_cmp_le_i32 s[18:19], 11, v175
  v_mfma_f32_16x16x32_bf16 v[28:31], v[132:135], v[20:23], v[28:31]
  v_cmp_le_i32 s[20:21], 16, v175
  v_cmp_le_i32 s[22:23], 17, v175
  v_cmp_le_i32 s[40:41], 18, v175
  v_cmp_le_i32 s[42:43], 19, v175
  v_cmp_le_i32 s[44:45], 24, v175
  s_waitcnt lgkmcnt(4)
  v_mfma_f32_32x32x16_bf16 v[40:55], v[36:39], v[212:215], v[40:55]
  ds_read_b64_tr_b16 v[128:129], v13 offset:16384
  ds_read_b64_tr_b16 v[130:131], v13 offset:16896
  v_cmp_le_i32 s[46:47], 25, v175
  v_cmp_le_i32 s[64:65], 26, v175
  v_cmp_le_i32 s[66:67], 27, v175
  v_lshlrev_b32 v176, 4, v191
  v_lshl_add_u32 v176, v190, 5, v176
  v_mfma_f32_32x32x16_bf16 v[56:71], v[76:79], v[212:215], v[56:71]
  ds_read_b64_tr_b16 v[132:133], v13 offset:24576
  ds_read_b64_tr_b16 v[134:135], v13 offset:25088
  v_bfe_u32 v190, v0, 2, 2
  v_lshl_add_u32 v190, v191, 2, v190
  v_and_b32 v175, 1, v0
  v_lshlrev_b32 v175, 4, v175
  v_lshl_add_u32 v177, v190, 5, v175
  s_waitcnt lgkmcnt(0)
  s_waitcnt vmcnt(7)
  s_barrier
  v_mfma_f32_32x32x16_bf16 v[40:55], v[6:9], v[216:219], v[40:55]
  v_add_u32 v10, 40960, v10
  v_add_u32 v11, 40960, v11
  v_add_u32 v12, 40960, v12
  v_add_u32 v13, 40960, v13
  ds_read_b64_tr_b16 v[36:37], v10 offset:0
  ds_read_b64_tr_b16 v[38:39], v10 offset:512
  v_bfe_u32 v175, v0, 1, 1
  v_lshl_add_u32 v177, v175, 3, v177
  v_lshlrev_b32 v179, 7, v190
  v_bfe_u32 v175, v0, 3, 1
  s_bfe_u32 s97, s56, 0x10001
  v_xor_b32 v175, s97, v175
  v_mfma_f32_32x32x16_bf16 v[56:71], v[32:35], v[216:219], v[56:71]
  s_add_u32 m0, s72, 40960
  s_lshl_b32 s68, s87, 18
  s_add_u32 s68, s68, 131072
  ds_read_b64_tr_b16 v[76:77], v10 offset:8192
  ds_read_b64_tr_b16 v[78:79], v10 offset:8704
  v_lshl_add_u32 v179, v175, 6, v179
  v_bfe_u32 v175, v0, 4, 1
  v_lshl_add_u32 v179, v175, 5, v179
  v_and_b32 v175, 3, v0
  v_lshl_add_u32 v179, v175, 3, v179
  buffer_load_dwordx4 v3, s[32:35], s68 offen lds
  v_mfma_f32_32x32x16_bf16 v[40:55], v[128:131], v[220:223], v[40:55]
  ds_read_b64_tr_b16 v[6:7], v11 offset:0
  ds_read_b64_tr_b16 v[8:9], v11 offset:512
  s_lshl_b32 s70, s58, 10
  v_add_u32 v180, s70, v72
  v_bfe_u32 v175, v0, 4, 1
  v_xor_b32 v175, 1, v175
  v_lshlrev_b32 v178, 10, v175
  s_add_u32 s69, s90, 4294950784
  v_mfma_f32_32x32x16_bf16 v[56:71], v[132:135], v[220:223], v[56:71]
  ds_read_b64_tr_b16 v[32:33], v11 offset:8192
  ds_read_b64_tr_b16 v[34:35], v11 offset:8704
  v_mul_lo_u32 v190, v175, s69
  v_add_u32 v177, v177, v190
  v_add_u32 v177, 159872, v177
  buffer_load_dwordx4 v2, s[32:35], s68 offen offset:1024 lds
  s_waitcnt lgkmcnt(4)
  v_mfma_f32_32x32x16_bf16 v[40:55], v[36:39], v[224:227], v[40:55]
  ds_read_b64_tr_b16 v[128:129], v12 offset:0
  ds_read_b64_tr_b16 v[130:131], v12 offset:512
  v_mfma_f32_16x16x32_bf16 v[24:27], v[36:39], v[20:23], v[24:27]
  s_add_u32 m0, s72, 57344
  s_lshl_b32 s68, s87, 18
  s_add_u32 s68, s68, 196608
  ds_read_b64_tr_b16 v[132:133], v12 offset:8192
  ds_read_b64_tr_b16 v[134:135], v12 offset:8704
  buffer_load_dwordx4 v3, s[32:35], s68 offen lds
  v_mfma_f32_32x32x16_bf16 v[56:71], v[76:79], v[224:227], v[56:71]
  v_mfma_f32_16x16x32_bf16 v[28:31], v[76:79], v[20:23], v[28:31]
  s_waitcnt lgkmcnt(4)
  v_mfma_f32_32x32x16_bf16 v[40:55], v[6:9], v[228:231], v[40:55]
  ds_read_b64_tr_b16 v[36:37], v13 offset:0
  ds_read_b64_tr_b16 v[38:39], v13 offset:512
  v_mfma_f32_32x32x16_bf16 v[56:71], v[32:35], v[228:231], v[56:71]
  ds_read_b64_tr_b16 v[76:77], v13 offset:8192
  ds_read_b64_tr_b16 v[78:79], v13 offset:8704
  buffer_load_dwordx4 v2, s[32:35], s68 offen offset:1024 lds
  s_lshl_b32 s76, s82, 8
  s_sub_i32 s76, s76, 256
  s_max_i32 s76, s76, 0
  s_add_u32 s76, s76, 15728640
  s_cmp_eq_u32 s56, 0
  s_cbranch_scc1 R4
B4:
  s_waitcnt lgkmcnt(4)
  v_mfma_f32_32x32x16_bf16 v[40:55], v[128:131], v[232:235], v[40:55]
  ds_read_b64_tr_b16 v[6:7], v10 offset:16384
  ds_read_b64_tr_b16 v[8:9], v10 offset:16896
  v_mfma_f32_32x32x16_bf16 v[56:71], v[132:135], v[232:235], v[56:71]
  ds_read_b64_tr_b16 v[32:33], v10 offset:24576
  ds_read_b64_tr_b16 v[34:35], v10 offset:25088
  s_waitcnt lgkmcnt(4)
  v_mfma_f32_32x32x16_bf16 v[40:55], v[36:39], v[236:239], v[40:55]
  ds_read_b64_tr_b16 v[128:129], v11 offset:16384
  ds_read_b64_tr_b16 v[130:131], v11 offset:16896
  v_mfma_f32_32x32x16_bf16 v[56:71], v[76:79], v[236:239], v[56:71]
  ds_read_b64_tr_b16 v[132:133], v11 offset:24576
  ds_read_b64_tr_b16 v[134:135], v11 offset:25088
  s_waitcnt lgkmcnt(4)
  v_mfma_f32_32x32x16_bf16 v[40:55], v[6:9], v[240:243], v[40:55]
  ds_read_b64_tr_b16 v[36:37], v12 offset:16384
  ds_read_b64_tr_b16 v[38:39], v12 offset:16896
  v_mfma_f32_16x16x32_bf16 v[24:27], v[6:9], v[20:23], v[24:27]
  ds_read_b64_tr_b16 v[76:77], v12 offset:24576
  ds_read_b64_tr_b16 v[78:79], v12 offset:25088
  v_mfma_f32_32x32x16_bf16 v[56:71], v[32:35], v[240:243], v[56:71]
  v_mfma_f32_16x16x32_bf16 v[28:31], v[32:35], v[20:23], v[28:31]
  s_waitcnt lgkmcnt(4)
  v_mfma_f32_32x32x16_bf16 v[40:55], v[128:131], v[244:247], v[40:55]
  ds_read_b64_tr_b16 v[6:7], v13 offset:16384
  ds_read_b64_tr_b16 v[8:9], v13 offset:16896
  v_mfma_f32_32x32x16_bf16 v[56:71], v[132:135], v[244:247], v[56:71]
  ds_read_b64_tr_b16 v[32:33], v13 offset:24576
  ds_read_b64_tr_b16 v[34:35], v13 offset:25088
  ds_write_b128 v172, v[24:27]
  ds_write_b128 v172, v[28:31] offset:128
  s_cmp_eq_u32 s56, 0
  s_cbranch_scc1 R6
B6:
  s_waitcnt vmcnt(4)
  s_waitcnt vmcnt(0)
  s_waitcnt lgkmcnt(0)
  s_barrier
  s_cmp_eq_u32 s56, 0
  s_cbranch_scc1 R7
B7:
  s_lshl_b32 s68, s82, 8
  s_lshl_b32 s69, s56, 6
  s_add_u32 s69, s69, s68
  s_sub_i32 s69, s69, 256
  s_max_i32 s69, s69, 0
  s_lshl_b32 s69, s69, 5
  s_lshl_b32 s70, s81, 16
  s_add_u32 m0, s72, 126976
  s_add_u32 s69, s69, s70
  s_add_u32 s71, s69, 13631488
  s_add_u32 s69, s69, 11534336
  buffer_load_dwordx4 v72, s[48:51], s69 offen lds
  buffer_load_dwordx4 v72, s[48:51], s69 offen offset:1024 lds
  s_add_u32 m0, s72, 143360
  s_nop 0
  buffer_load_dwordx4 v72, s[48:51], s71 offen lds
  buffer_load_dwordx4 v72, s[48:51], s71 offen offset:1024 lds
  v_mfma_f32_32x32x16_bf16 v[40:55], v[36:39], v[248:251], v[40:55]
  ds_read_b64 v[144:145], v173 offset:0
  ds_read_b64 v[146:147], v173 offset:384
  ds_read_b64 v[148:149], v173 offset:768
  ds_read_b64 v[150:151], v173 offset:1152
  v_mfma_f32_32x32x16_bf16 v[56:71], v[76:79], v[248:251], v[56:71]
  s_waitcnt lgkmcnt(0)
  v_add_f32 v144, v144, v146
  v_add_f32 v145, v145, v147
  v_add_f32 v148, v148, v150
  v_add_f32 v149, v149, v151
  v_add_f32 v144, v144, v148
  v_mfma_f32_32x32x16_bf16 v[40:55], v[6:9], v[252:255], v[40:55]
  v_add_f32 v145, v145, v149
  ds_write_b64 v174, v[144:145]
  v_mfma_f32_32x32x16_bf16 v[56:71], v[32:35], v[252:255], v[56:71]
  s_branch L_e1
L_p1b:
  s_add_u32 s97, s74, 1
  s_cmp_lt_u32 s97, 8
  s_cselect_b32 s77, 0x3eb8aa3b, 1.0
  s_lshl_b32 s97, s97, 2
  s_lshl_b32 s98, s58, 1
  s_add_u32 s97, s97, s98
  s_lshl_b32 s97, s97, 16
  s_add_u32 s97, s97, 9437184
  s_add_u32 s98, s97, 0x10000
  v_mul_f32 v60, s77, v15
  v_mul_f32 v96, v60, v96
  v_mul_f32 v97, v60, v97
  v_mul_f32 v98, v60, v98
  v_mul_f32 v99, v60, v99
  v_mul_f32 v100, v60, v100
  v_mul_f32 v101, v60, v101
  v_mul_f32 v102, v60, v102
  v_mul_f32 v103, v60, v103
  v_cvt_pk_bf16_f32 v52, v96, v97
  v_cvt_pk_bf16_f32 v53, v98, v99
  v_cvt_pk_bf16_f32 v54, v100, v101
  v_cvt_pk_bf16_f32 v55, v102, v103
  buffer_store_dwordx4 v[52:55], v1, s[48:51], s97 offen sc1
  v_mul_f32 v104, v60, v104
  v_mul_f32 v105, v60, v105
  v_mul_f32 v106, v60, v106
  v_mul_f32 v107, v60, v107
  v_mul_f32 v108, v60, v108
  v_mul_f32 v109, v60, v109
  v_mul_f32 v110, v60, v110
  v_mul_f32 v111, v60, v111
  v_cvt_pk_bf16_f32 v56, v104, v105
  v_cvt_pk_bf16_f32 v57, v106, v107
  v_cvt_pk_bf16_f32 v58, v108, v109
  v_cvt_pk_bf16_f32 v59, v110, v111
  buffer_store_dwordx4 v[56:59], v1, s[48:51], s98 offen sc1
  s_add_u32 s97, s74, 2
  s_cmp_lt_u32 s97, 8
  s_cselect_b32 s77, 0x3eb8aa3b, 1.0
  s_lshl_b32 s97, s97, 2
  s_lshl_b32 s98, s58, 1
  s_add_u32 s97, s97, s98
  s_lshl_b32 s97, s97, 16
  s_add_u32 s97, s97, 9437184
  s_add_u32 s98, s97, 0x10000
  v_mul_f32 v48, s77, v15
  v_mul_f32 v112, v48, v112
  v_mul_f32 v113, v48, v113
  v_mul_f32 v114, v48, v114
  v_mul_f32 v115, v48, v115
  v_mul_f32 v116, v48, v116
  v_mul_f32 v117, v48, v117
  v_mul_f32 v118, v48, v118
  v_mul_f32 v119, v48, v119
  v_cvt_pk_bf16_f32 v40, v112, v113
  v_cvt_pk_bf16_f32 v41, v114, v115
  v_cvt_pk_bf16_f32 v42, v116, v117
  v_cvt_pk_bf16_f32 v43, v118, v119
  buffer_store_dwordx4 v[40:43], v1, s[48:51], s97 offen sc1
  v_mul_f32 v120, v48, v120
  v_mul_f32 v121, v48, v121
  v_mul_f32 v122, v48, v122
  v_mul_f32 v123, v48, v123
  v_mul_f32 v124, v48, v124
  v_mul_f32 v125, v48, v125
  v_mul_f32 v126, v48, v126
  v_mul_f32 v127, v48, v127
  v_cvt_pk_bf16_f32 v44, v120, v121
  v_cvt_pk_bf16_f32 v45, v122, v123
  v_cvt_pk_bf16_f32 v46, v124, v125
  v_cvt_pk_bf16_f32 v47, v126, v127
  buffer_store_dwordx4 v[44:47], v1, s[48:51], s98 offen sc1
  ds_read_b64_tr_b16 v[36:37], v10 offset:0
  ds_read_b64_tr_b16 v[38:39], v10 offset:512
  ds_read_b64_tr_b16 v[76:77], v10 offset:8192
  ds_read_b64_tr_b16 v[78:79], v10 offset:8704
  ds_read_b64_tr_b16 v[6:7], v11 offset:0
  ds_read_b64_tr_b16 v[8:9], v11 offset:512
  ds_read_b64_tr_b16 v[32:33], v11 offset:8192
  ds_read_b64_tr_b16 v[34:35], v11 offset:8704
  s_waitcnt lgkmcnt(4)
  v_mfma_f32_32x32x16_bf16 v[40:55], v[36:39], v[128:131], 0
  s_lshl_b32 s79, s59, 4
  s_lshl_b32 s69, s60, 2
  s_add_u32 s69, s69, s61
  s_add_u32 s79, s79, s69
  s_lshr_b32 s82, s59, 1
  s_and_b32 s81, s79, 31
  s_lshl_b32 s84, s60, 3
  s_add_u32 s84, s84, s63
  v_mfma_f32_16x16x32_bf16 v[24:27], v[36:39], v[20:23], 0
  s_and_b32 s85, s2, 1
  s_lshl_b32 s85, s85, 2
  s_add_u32 s85, s85, s61
  s_and_b32 s86, s56, 3
  s_lshr_b32 s87, s56, 2
  s_lshl_b32 s83, s86, 1
  s_sub_u32 s83, 8, s83
  s_cmp_eq_u32 s82, 0
  s_cselect_b32 s83, s83, 0
  v_mfma_f32_32x32x16_bf16 v[56:71], v[76:79], v[128:131], 0
  v_and_b32 v2, 7, v0
  v_bfe_u32 v19, v0, 4, 1
  v_lshlrev_b32 v19, 2, v19
  v_xor_b32 v2, v2, v19
  v_mfma_f32_16x16x32_bf16 v[28:31], v[76:79], v[20:23], 0
  ds_read_b64_tr_b16 v[128:129], v12 offset:0
  ds_read_b64_tr_b16 v[130:131], v12 offset:512
  v_lshlrev_b32 v2, 4, v2
  v_lshrrev_b32 v19, 3, v0
  v_lshl_add_u32 v3, v19, 10, v2
  s_lshl_b32 s69, s85, 7
  s_lshl_b32 s70, s86, 14
  s_waitcnt lgkmcnt(2)
  v_mfma_f32_32x32x16_bf16 v[40:55], v[6:9], v[132:135], v[40:55]
  s_add_u32 s69, s69, s70
  v_add_u32 v3, s69, v3
  v_add_u32 v2, 7168, v3
  s_mov_b32 s28, s16
  s_and_b32 s29, s17, 0xffff
  s_mov_b32 s30, 1835008
  v_mfma_f32_32x32x16_bf16 v[56:71], v[32:35], v[132:135], v[56:71]
  ds_read_b64_tr_b16 v[132:133], v12 offset:8192
  ds_read_b64_tr_b16 v[134:135], v12 offset:8704
  ds_read_b64_tr_b16 v[36:37], v13 offset:0
  ds_read_b64_tr_b16 v[38:39], v13 offset:512
  ds_read_b64_tr_b16 v[76:77], v13 offset:8192
  ds_read_b64_tr_b16 v[78:79], v13 offset:8704
  s_mov_b32 s32, s8
  s_and_b32 s33, s9, 0xffff
  s_mov_b32 s34, 524288
  s_mov_b32 s36, s18
  s_and_b32 s37, s19, 0xffff
  s_mov_b32 s38, 2097152
  s_lshl_b32 s88, s84, 11
  s_lshl_b32 s69, s86, 16
  s_waitcnt lgkmcnt(4)
  v_mfma_f32_32x32x16_bf16 v[40:55], v[128:131], v[136:139], v[40:55]
  ds_read_b64_tr_b16 v[6:7], v10 offset:16384
  ds_read_b64_tr_b16 v[8:9], v10 offset:16896
  s_add_u32 s88, s88, s69
  s_lshl_b32 s69, s61, 1
  s_add_u32 s89, s63, s69
  s_and_b32 s89, s89, 0
  s_sub_u32 s69, s89, 6
  s_min_u32 s63, s89, s69
  s_lshl_b32 s90, s86, 11
  v_mfma_f32_32x32x16_bf16 v[56:71], v[132:135], v[136:139], v[56:71]
  ds_read_b64_tr_b16 v[32:33], v10 offset:24576
  ds_read_b64_tr_b16 v[34:35], v10 offset:25088
  s_waitcnt lgkmcnt(4)
  v_mfma_f32_32x32x16_bf16 v[40:55], v[36:39], v[140:143], v[40:55]
  ds_read_b64_tr_b16 v[128:129], v11 offset:16384
  ds_read_b64_tr_b16 v[130:131], v11 offset:16896
  v_mfma_f32_32x32x16_bf16 v[56:71], v[76:79], v[140:143], v[56:71]
  ds_read_b64_tr_b16 v[132:133], v11 offset:24576
  ds_read_b64_tr_b16 v[134:135], v11 offset:25088
  s_waitcnt lgkmcnt(4)
  v_mfma_f32_32x32x16_bf16 v[40:55], v[6:9], v[144:147], v[40:55]
  ds_read_b64_tr_b16 v[36:37], v12 offset:16384
  ds_read_b64_tr_b16 v[38:39], v12 offset:16896
  v_mfma_f32_16x16x32_bf16 v[24:27], v[6:9], v[20:23], v[24:27]
  ds_read_b64_tr_b16 v[76:77], v12 offset:24576
  ds_read_b64_tr_b16 v[78:79], v12 offset:25088
  v_mfma_f32_32x32x16_bf16 v[56:71], v[32:35], v[144:147], v[56:71]
  v_mfma_f32_16x16x32_bf16 v[28:31], v[32:35], v[20:23], v[28:31]
  s_waitcnt lgkmcnt(4)
  v_mfma_f32_32x32x16_bf16 v[40:55], v[128:131], v[148:151], v[40:55]
  ds_read_b64_tr_b16 v[6:7], v13 offset:16384
  ds_read_b64_tr_b16 v[8:9], v13 offset:16896
  v_mfma_f32_32x32x16_bf16 v[56:71], v[132:135], v[148:151], v[56:71]
  ds_read_b64_tr_b16 v[32:33], v13 offset:24576
  ds_read_b64_tr_b16 v[34:35], v13 offset:25088
  s_waitcnt lgkmcnt(0)
  s_waitcnt vmcnt(10)
  s_barrier
  s_mov_b32 m0, 161152
  s_mov_b32 s99, 1310720
  s_mov_b64 exec, 15
  buffer_load_dword v74, s[20:23], s99 offen lds
  s_mov_b64 exec, -1
  v_mfma_f32_32x32x16_bf16 v[40:55], v[36:39], v[152:155], v[40:55]
  v_add_u32 v10, 4294885376, v10
  v_add_u32 v11, 4294885376, v11
  v_add_u32 v12, 4294885376, v12
  v_add_u32 v13, 4294885376, v13
  ds_read_b64_tr_b16 v[128:129], v10 offset:0
  ds_read_b64_tr_b16 v[130:131], v10 offset:512
  v_mfma_f32_32x32x16_bf16 v[56:71], v[76:79], v[152:155], v[56:71]
  s_mov_b32 s66, 1376256
  s_add_u32 m0, s73, 81920
  ds_read_b64_tr_b16 v[132:133], v10 offset:8192
  ds_read_b64_tr_b16 v[134:135], v10 offset:8704
  buffer_load_dwordx4 v5, s[40:43], s66 offen lds
  v_mfma_f32_32x32x16_bf16 v[40:55], v[6:9], v[156:159], v[40:55]
  ds_read_b64_tr_b16 v[36:37], v11 offset:0
  ds_read_b64_tr_b16 v[38:39], v11 offset:512
  v_mfma_f32_32x32x16_bf16 v[56:71], v[32:35], v[156:159], v[56:71]
  s_add_u32 m0, s73, 90112
  ds_read_b64_tr_b16 v[76:77], v11 offset:8192
  ds_read_b64_tr_b16 v[78:79], v11 offset:8704
  buffer_load_dwordx4 v5, s[44:47], s66 offen lds
  s_waitcnt lgkmcnt(4)
  v_mfma_f32_32x32x16_bf16 v[40:55], v[128:131], v[160:163], v[40:55]
  ds_read_b64_tr_b16 v[6:7], v12 offset:0
  ds_read_b64_tr_b16 v[8:9], v12 offset:512
  v_mfma_f32_16x16x32_bf16 v[24:27], v[128:131], v[20:23], v[24:27]
  s_mov_b32 s67, 1605632
  s_add_u32 m0, s73, 98304
  ds_read_b64_tr_b16 v[32:33], v12 offset:8192
  ds_read_b64_tr_b16 v[34:35], v12 offset:8704
  buffer_load_dwordx4 v5, s[40:43], s67 offen lds
  v_mfma_f32_32x32x16_bf16 v[56:71], v[132:135], v[160:163], v[56:71]
  v_mfma_f32_16x16x32_bf16 v[28:31], v[132:135], v[20:23], v[28:31]
  s_waitcnt lgkmcnt(4)
  v_mfma_f32_32x32x16_bf16 v[40:55], v[36:39], v[164:167], v[40:55]
  ds_read_b64_tr_b16 v[128:129], v13 offset:0
  ds_read_b64_tr_b16 v[130:131], v13 offset:512
  v_mfma_f32_32x32x16_bf16 v[56:71], v[76:79], v[164:167], v[56:71]
  s_add_u32 m0, s73, 106496
  ds_read_b64_tr_b16 v[132:133], v13 offset:8192
  ds_read_b64_tr_b16 v[134:135], v13 offset:8704
  buffer_load_dwordx4 v5, s[44:47], s67 offen lds
  s_waitcnt lgkmcnt(4)
  v_mfma_f32_32x32x16_bf16 v[40:55], v[6:9], v[168:171], v[40:55]
  ds_read_b64_tr_b16 v[36:37], v10 offset:16384
  ds_read_b64_tr_b16 v[38:39], v10 offset:16896
  v_mfma_f32_32x32x16_bf16 v[56:71], v[32:35], v[168:171], v[56:71]
  ds_read_b64_tr_b16 v[76:77], v10 offset:24576
  ds_read_b64_tr_b16 v[78:79], v10 offset:25088
  s_waitcnt lgkmcnt(4)
  v_mfma_f32_32x32x16_bf16 v[40:55], v[128:131], v[172:175], v[40:55]
  ds_read_b64_tr_b16 v[6:7], v11 offset:16384
  ds_read_b64_tr_b16 v[8:9], v11 offset:16896
  v_mfma_f32_32x32x16_bf16 v[56:71], v[132:135], v[172:175], v[56:71]
  ds_read_b64_tr_b16 v[32:33], v11 offset:24576
  ds_read_b64_tr_b16 v[34:35], v11 offset:25088
  s_waitcnt lgkmcnt(4)
  v_mfma_f32_32x32x16_bf16 v[40:55], v[36:39], v[176:179], v[40:55]
  ds_read_b64_tr_b16 v[128:129], v12 offset:16384
  ds_read_b64_tr_b16 v[130:131], v12 offset:16896
  v_mfma_f32_16x16x32_bf16 v[24:27], v[36:39], v[20:23], v[24:27]
  ds_read_b64_tr_b16 v[132:133], v12 offset:24576
  ds_read_b64_tr_b16 v[134:135], v12 offset:25088
  v_mfma_f32_32x32x16_bf16 v[56:71], v[76:79], v[176:179], v[56:71]
  v_mfma_f32_16x16x32_bf16 v[28:31], v[76:79], v[20:23], v[28:31]
  s_waitcnt lgkmcnt(4)
  v_mfma_f32_32x32x16_bf16 v[40:55], v[6:9], v[180:183], v[40:55]
  ds_read_b64_tr_b16 v[36:37], v13 offset:16384
  ds_read_b64_tr_b16 v[38:39], v13 offset:16896
  v_mfma_f32_32x32x16_bf16 v[56:71], v[32:35], v[180:183], v[56:71]
  ds_read_b64_tr_b16 v[76:77], v13 offset:24576
  ds_read_b64_tr_b16 v[78:79], v13 offset:25088
  s_waitcnt lgkmcnt(0)
  s_waitcnt vmcnt(5)
  s_barrier
  s_mov_b32 m0, 161152
  s_mov_b32 s99, 1572864
  s_mov_b64 exec, 15
  buffer_load_dword v74, s[20:23], s99 offen lds
  s_mov_b64 exec, -1
  s_cmp_eq_u32 s56, 0
  s_cbranch_scc1 R8
B8:
  v_mfma_f32_32x32x16_bf16 v[40:55], v[128:131], v[184:187], v[40:55]
  v_add_u32 v10, 40960, v10
  v_add_u32 v11, 40960, v11
  v_add_u32 v12, 40960, v12
  v_add_u32 v13, 40960, v13
  ds_read_b64_tr_b16 v[6:7], v10 offset:0
  ds_read_b64_tr_b16 v[8:9], v10 offset:512
  v_mfma_f32_32x32x16_bf16 v[56:71], v[132:135], v[184:187], v[56:71]
  s_add_u32 m0, s72, 0
  s_lshl_b32 s68, s87, 18
  s_add_u32 s68, s68, 0
  ds_read_b64_tr_b16 v[32:33], v10 offset:8192
  ds_read_b64_tr_b16 v[34:35], v10 offset:8704
  buffer_load_dwordx4 v3, s[32:35], s68 offen lds
  v_mfma_f32_32x32x16_bf16 v[40:55], v[36:39], v[188:191], v[40:55]
  ds_read_b64_tr_b16 v[128:129], v11 offset:0
  ds_read_b64_tr_b16 v[130:131], v11 offset:512
  v_mfma_f32_32x32x16_bf16 v[56:71], v[76:79], v[188:191], v[56:71]
  ds_read_b64_tr_b16 v[132:133], v11 offset:8192
  ds_read_b64_tr_b16 v[134:135], v11 offset:8704
  buffer_load_dwordx4 v2, s[32:35], s68 offen offset:1024 lds
  s_waitcnt lgkmcnt(4)
  v_mfma_f32_32x32x16_bf16 v[40:55], v[6:9], v[192:195], v[40:55]
  ds_read_b64_tr_b16 v[36:37], v12 offset:0
  ds_read_b64_tr_b16 v[38:39], v12 offset:512
  v_mfma_f32_16x16x32_bf16 v[24:27], v[6:9], v[20:23], v[24:27]
  s_add_u32 m0, s72, 16384
  s_lshl_b32 s68, s87, 18
  s_add_u32 s68, s68, 65536
  ds_read_b64_tr_b16 v[76:77], v12 offset:8192
  ds_read_b64_tr_b16 v[78:79], v12 offset:8704
  buffer_load_dwordx4 v3, s[32:35], s68 offen lds
  v_mfma_f32_32x32x16_bf16 v[56:71], v[32:35], v[192:195], v[56:71]
  v_mfma_f32_16x16x32_bf16 v[28:31], v[32:35], v[20:23], v[28:31]
  s_waitcnt lgkmcnt(4)
  v_mfma_f32_32x32x16_bf16 v[40:55], v[128:131], v[196:199], v[40:55]
  ds_read_b64_tr_b16 v[6:7], v13 offset:0
  ds_read_b64_tr_b16 v[8:9], v13 offset:512
  v_lshrrev_b32 v172, 4, v0
  v_lshlrev_b32 v172, 4, v172
  v_and_b32 v173, 1, v0
  v_lshl_add_u32 v172, v173, 6, v172
  s_lshl_b32 s69, s58, 2
  s_add_u32 s69, s69, s57
  v_mfma_f32_32x32x16_bf16 v[56:71], v[132:135], v[196:199], v[56:71]
  ds_read_b64_tr_b16 v[32:33], v13 offset:8192
  ds_read_b64_tr_b16 v[34:35], v13 offset:8704
  s_mul_i32 s69, s69, 384
  s_add_u32 s69, s69, 122880
  v_add_u32 v172, s69, v172
  v_min_u32 v173, 47, v0
  v_lshlrev_b32 v173, 3, v173
  s_mul_i32 s69, s58, 384
  s_add_u32 s69, s69, 125952
  buffer_load_dwordx4 v2, s[32:35], s68 offen offset:1024 lds
  s_waitcnt lgkmcnt(4)
  v_mfma_f32_32x32x16_bf16 v[40:55], v[36:39], v[200:203], v[40:55]
  ds_read_b64_tr_b16 v[128:129], v10 offset:16384
  ds_read_b64_tr_b16 v[130:131], v10 offset:16896
  v_add_u32 v174, s69, v173
  s_mul_i32 s70, s58, 1536
  s_add_u32 s70, s70, 122880
  v_add_u32 v173, s70, v173
  v_lshrrev_b32 v167, 5, v0
  v_lshlrev_b32 v167, 4, v167
  v_mfma_f32_32x32x16_bf16 v[56:71], v[76:79], v[200:203], v[56:71]
  ds_read_b64_tr_b16 v[132:133], v10 offset:24576
  ds_read_b64_tr_b16 v[134:135], v10 offset:25088
  v_add_u32 v167, s69, v167
  v_and_b32 v190, 31, v0
  v_lshrrev_b32 v191, 5, v0
  v_lshlrev_b32 v175, 2, v191
  v_sub_u32 v175, v190, v175
  s_waitcnt lgkmcnt(4)
  v_mfma_f32_32x32x16_bf16 v[40:55], v[6:9], v[204:207], v[40:55]
  ds_read_b64_tr_b16 v[36:37], v11 offset:16384
  ds_read_b64_tr_b16 v[38:39], v11 offset:16896
  v_cmp_le_i32 s[4:5], 0, v175
  v_cmp_le_i32 s[6:7], 1, v175
  v_cmp_le_i32 s[8:9], 2, v175
  v_cmp_le_i32 s[10:11], 3, v175
  v_cmp_le_i32 s[12:13], 8, v175
  v_mfma_f32_32x32x16_bf16 v[56:71], v[32:35], v[204:207], v[56:71]
  ds_read_b64_tr_b16 v[76:77], v11 offset:24576
  ds_read_b64_tr_b16 v[78:79], v11 offset:25088
  v_cmp_le_i32 s[14:15], 9, v175
  v_cmp_le_i32 s[16:17], 10, v175
  v_cmp_le_i32 s[18:19], 11, v175
  v_cmp_le_i32 s[20:21], 16, v175
  v_cmp_le_i32 s[22:23], 17, v175
  s_waitcnt lgkmcnt(4)
  v_mfma_f32_32x32x16_bf16 v[40:55], v[128:131], v[208:211], v[40:55]
  ds_read_b64_tr_b16 v[6:7], v12 offset:16384
  ds_read_b64_tr_b16 v[8:9], v12 offset:16896
  v_cmp_le_i32 s[40:41], 18, v175
  v_cmp_le_i32 s[42:43], 19, v175
  v_cmp_le_i32 s[44:45], 24, v175
  v_cmp_le_i32 s[46:47], 25, v175
  v_cmp_le_i32 s[64:65], 26, v175
  v_mfma_f32_16x16x32_bf16 v[24:27], v[128:131], v[20:23], v[24:27]
  ds_read_b64_tr_b16 v[32:33], v12 offset:24576
  ds_read_b64_tr_b16 v[34:35], v12 offset:25088
  v_cmp_le_i32 s[66:67], 27, v175
  v_lshlrev_b32 v176, 4, v191
  v_lshl_add_u32 v176, v190, 5, v176
  v_bfe_u32 v190, v0, 2, 2
  v_lshl_add_u32 v190, v191, 2, v190
  v_mfma_f32_32x32x16_bf16 v[56:71], v[132:135], v[208:211], v[56:71]
  v_and_b32 v175, 1, v0
  v_lshlrev_b32 v175, 4, v175
  v_lshl_add_u32 v177, v190, 5, v175
  v_bfe_u32 v175, v0, 1, 1
  v_lshl_add_u32 v177, v175, 3, v177
  v_mfma_f32_16x16x32_bf16 v[28:31], v[132:135], v[20:23], v[28:31]
  v_lshlrev_b32 v179, 7, v190
  v_bfe_u32 v175, v0, 3, 1
  s_bfe_u32 s97, s56, 0x10001
  v_xor_b32 v175, s97, v175
  v_lshl_add_u32 v179, v175, 6, v179
  v_bfe_u32 v175, v0, 4, 1
  s_waitcnt lgkmcnt(4)
  v_mfma_f32_32x32x16_bf16 v[40:55], v[36:39], v[212:215], v[40:55]
  ds_read_b64_tr_b16 v[128:129], v13 offset:16384
  ds_read_b64_tr_b16 v[130:131], v13 offset:16896
  v_lshl_add_u32 v179, v175, 5, v179
  v_and_b32 v175, 3, v0
  v_lshl_add_u32 v179, v175, 3, v179
  s_lshl_b32 s70, s58, 10
  v_add_u32 v180, s70, v72
  v_bfe_u32 v175, v0, 4, 1
  v_mfma_f32_32x32x16_bf16 v[56:71], v[76:79], v[212:215], v[56:71]
  ds_read_b64_tr_b16 v[132:133], v13 offset:24576
  ds_read_b64_tr_b16 v[134:135], v13 offset:25088
  v_xor_b32 v175, 1, v175
  v_lshlrev_b32 v178, 10, v175
  s_add_u32 s69, s90, 4294950784
  v_mul_lo_u32 v190, v175, s69
  v_add_u32 v177, v177, v190
  v_add_u32 v177, 159872, v177
  s_waitcnt lgkmcnt(0)
  s_waitcnt vmcnt(5)
  s_barrier
  v_mfma_f32_32x32x16_bf16 v[40:55], v[6:9], v[216:219], v[40:55]
  v_add_u32 v10, 40960, v10
  v_add_u32 v11, 40960, v11
  v_add_u32 v12, 40960, v12
  v_add_u32 v13, 40960, v13
  ds_read_b64_tr_b16 v[36:37], v10 offset:0
  ds_read_b64_tr_b16 v[38:39], v10 offset:512
  v_mfma_f32_32x32x16_bf16 v[56:71], v[32:35], v[216:219], v[56:71]
  s_add_u32 m0, s72, 40960
  s_lshl_b32 s68, s87, 18
  s_add_u32 s68, s68, 131072
  ds_read_b64_tr_b16 v[76:77], v10 offset:8192
  ds_read_b64_tr_b16 v[78:79], v10 offset:8704
  buffer_load_dwordx4 v3, s[32:35], s68 offen lds
  v_mfma_f32_32x32x16_bf16 v[40:55], v[128:131], v[220:223], v[40:55]
  ds_read_b64_tr_b16 v[6:7], v11 offset:0
  ds_read_b64_tr_b16 v[8:9], v11 offset:512
  v_mfma_f32_32x32x16_bf16 v[56:71], v[132:135], v[220:223], v[56:71]
  ds_read_b64_tr_b16 v[32:33], v11 offset:8192
  ds_read_b64_tr_b16 v[34:35], v11 offset:8704
  buffer_load_dwordx4 v2, s[32:35], s68 offen offset:1024 lds
  s_waitcnt lgkmcnt(4)
  v_mfma_f32_32x32x16_bf16 v[40:55], v[36:39], v[224:227], v[40:55]
  ds_read_b64_tr_b16 v[128:129], v12 offset:0
  ds_read_b64_tr_b16 v[130:131], v12 offset:512
  v_mfma_f32_16x16x32_bf16 v[24:27], v[36:39], v[20:23], v[24:27]
  s_add_u32 m0, s72, 57344
  s_lshl_b32 s68, s87, 18
  s_add_u32 s68, s68, 196608
  ds_read_b64_tr_b16 v[132:133], v12 offset:8192
  ds_read_b64_tr_b16 v[134:135], v12 offset:8704
  buffer_load_dwordx4 v3, s[32:35], s68 offen lds
  v_mfma_f32_32x32x16_bf16 v[56:71], v[76:79], v[224:227], v[56:71]
  v_mfma_f32_16x16x32_bf16 v[28:31], v[76:79], v[20:23], v[28:31]
  s_waitcnt lgkmcnt(4)
  v_mfma_f32_32x32x16_bf16 v[40:55], v[6:9], v[228:231], v[40:55]
  ds_read_b64_tr_b16 v[36:37], v13 offset:0
  ds_read_b64_tr_b16 v[38:39], v13 offset:512
  v_mfma_f32_32x32x16_bf16 v[56:71], v[32:35], v[228:231], v[56:71]
  ds_read_b64_tr_b16 v[76:77], v13 offset:8192
  ds_read_b64_tr_b16 v[78:79], v13 offset:8704
  buffer_load_dwordx4 v2, s[32:35], s68 offen offset:1024 lds
  s_lshl_b32 s76, s82, 8
  s_sub_i32 s76, s76, 256
  s_max_i32 s76, s76, 0
  s_add_u32 s76, s76, 15728640
  s_cmp_eq_u32 s56, 0
  s_cbranch_scc1 R9
B9:
  s_waitcnt lgkmcnt(4)
  v_mfma_f32_32x32x16_bf16 v[40:55], v[128:131], v[232:235], v[40:55]
  ds_read_b64_tr_b16 v[6:7], v10 offset:16384
  ds_read_b64_tr_b16 v[8:9], v10 offset:16896
  v_mfma_f32_32x32x16_bf16 v[56:71], v[132:135], v[232:235], v[56:71]
  ds_read_b64_tr_b16 v[32:33], v10 offset:24576
  ds_read_b64_tr_b16 v[34:35], v10 offset:25088
  s_waitcnt lgkmcnt(4)
  v_mfma_f32_32x32x16_bf16 v[40:55], v[36:39], v[236:239], v[40:55]
  ds_read_b64_tr_b16 v[128:129], v11 offset:16384
  ds_read_b64_tr_b16 v[130:131], v11 offset:16896
  v_mfma_f32_32x32x16_bf16 v[56:71], v[76:79], v[236:239], v[56:71]
  ds_read_b64_tr_b16 v[132:133], v11 offset:24576
  ds_read_b64_tr_b16 v[134:135], v11 offset:25088
  s_waitcnt lgkmcnt(4)
  v_mfma_f32_32x32x16_bf16 v[40:55], v[6:9], v[240:243], v[40:55]
  ds_read_b64_tr_b16 v[36:37], v12 offset:16384
  ds_read_b64_tr_b16 v[38:39], v12 offset:16896
  v_mfma_f32_16x16x32_bf16 v[24:27], v[6:9], v[20:23], v[24:27]
  ds_read_b64_tr_b16 v[76:77], v12 offset:24576
  ds_read_b64_tr_b16 v[78:79], v12 offset:25088
  v_mfma_f32_32x32x16_bf16 v[56:71], v[32:35], v[240:243], v[56:71]
  v_mfma_f32_16x16x32_bf16 v[28:31], v[32:35], v[20:23], v[28:31]
  s_waitcnt lgkmcnt(4)
  v_mfma_f32_32x32x16_bf16 v[40:55], v[128:131], v[244:247], v[40:55]
  ds_read_b64_tr_b16 v[6:7], v13 offset:16384
  ds_read_b64_tr_b16 v[8:9], v13 offset:16896
  v_mfma_f32_32x32x16_bf16 v[56:71], v[132:135], v[244:247], v[56:71]
  ds_read_b64_tr_b16 v[32:33], v13 offset:24576
  ds_read_b64_tr_b16 v[34:35], v13 offset:25088
  ds_write_b128 v172, v[24:27]
  ds_write_b128 v172, v[28:31] offset:128
  s_cmp_eq_u32 s56, 0
  s_cbranch_scc1 R11
B11:
  s_waitcnt vmcnt(0)
  s_waitcnt lgkmcnt(0)
  s_barrier
  s_cmp_eq_u32 s56, 0
  s_cbranch_scc1 R12
B12:
  s_lshl_b32 s68, s82, 8
  s_lshl_b32 s69, s56, 6
  s_add_u32 s69, s69, s68
  s_sub_i32 s69, s69, 256
  s_max_i32 s69, s69, 0
  s_lshl_b32 s69, s69, 5
  s_lshl_b32 s70, s81, 16
  s_add_u32 m0, s72, 126976
  s_add_u32 s69, s69, s70
  s_add_u32 s71, s69, 13631488
  s_add_u32 s69, s69, 11534336
  buffer_load_dwordx4 v72, s[48:51], s69 offen lds
  buffer_load_dwordx4 v72, s[48:51], s69 offen offset:1024 lds
  s_add_u32 m0, s72, 143360
  s_nop 0
  buffer_load_dwordx4 v72, s[48:51], s71 offen lds
  buffer_load_dwordx4 v72, s[48:51], s71 offen offset:1024 lds
  v_mfma_f32_32x32x16_bf16 v[40:55], v[36:39], v[248:251], v[40:55]
  ds_read_b64 v[144:145], v173 offset:0
  ds_read_b64 v[146:147], v173 offset:384
  ds_read_b64 v[148:149], v173 offset:768
  ds_read_b64 v[150:151], v173 offset:1152
  v_mfma_f32_32x32x16_bf16 v[56:71], v[76:79], v[248:251], v[56:71]
  s_waitcnt lgkmcnt(0)
  v_add_f32 v144, v144, v146
  v_add_f32 v145, v145, v147
  v_add_f32 v148, v148, v150
  v_add_f32 v149, v149, v151
  v_add_f32 v144, v144, v148
  v_mfma_f32_32x32x16_bf16 v[40:55], v[6:9], v[252:255], v[40:55]
  v_add_f32 v145, v145, v149
  ds_write_b64 v174, v[144:145]
  v_mfma_f32_32x32x16_bf16 v[56:71], v[32:35], v[252:255], v[56:71]
L_e1:
  s_cmp_eq_u32 s87, 1
  s_cbranch_scc1 L_B
  s_lshl_b32 s68, s82, 13
  s_add_u32 s68, s68, s90
  s_lshl_b32 s70, s81, 16
  s_add_u32 s68, s68, s70
  s_add_u32 s68, s68, 9437184
  buffer_load_dwordx4 v[76:79], v176, s[48:51], s68 offen
  buffer_load_dwordx4 v[112:115], v176, s[48:51], s68 offen offset:1024
  s_add_u32 s68, s90, 126976
  v_add_u32 v4, s68, v176
  v_mov_b32 v5, v177
  v_mov_b32 v6, v178
  v_mov_b32 v7, 0x5d800000
  v_mov_b32 v10, v179
  v_add_u32 v11, 40960, v179
  s_lshr_b32 s76, s84, 1
  s_lshl_b32 s76, s76, 7
  s_add_u32 s76, s76, 15732736
  ds_read_b128 v[80:83], v167 offset:0
  ds_read_b128 v[84:87], v167 offset:32
  ds_read_b128 v[88:91], v167 offset:64
  ds_read_b128 v[92:95], v167 offset:96
  ds_read_b128 v[96:99], v167 offset:128
  ds_read_b128 v[100:103], v167 offset:160
  ds_read_b128 v[104:107], v167 offset:192
  ds_read_b128 v[108:111], v167 offset:224
  s_waitcnt lgkmcnt(4)
  v_fmac_f32 v40, v14, v80
  v_fmac_f32 v41, v14, v81
  v_fmac_f32 v42, v14, v82
  v_fmac_f32 v43, v14, v83
  v_fmac_f32 v44, v14, v84
  v_fmac_f32 v45, v14, v85
  v_fmac_f32 v46, v14, v86
  v_fmac_f32 v47, v14, v87
  v_fmac_f32 v48, v14, v88
  v_fmac_f32 v49, v14, v89
  v_fmac_f32 v50, v14, v90
  v_fmac_f32 v51, v14, v91
  v_fmac_f32 v52, v14, v92
  v_fmac_f32 v53, v14, v93
  v_fmac_f32 v54, v14, v94
  v_fmac_f32 v55, v14, v95
  s_waitcnt lgkmcnt(0)
  v_fmac_f32 v56, v14, v96
  v_fmac_f32 v57, v14, v97
  v_fmac_f32 v58, v14, v98
  v_fmac_f32 v59, v14, v99
  v_fmac_f32 v60, v14, v100
  v_fmac_f32 v61, v14, v101
  v_fmac_f32 v62, v14, v102
  v_fmac_f32 v63, v14, v103
  v_fmac_f32 v64, v14, v104
  v_fmac_f32 v65, v14, v105
  v_fmac_f32 v66, v14, v106
  v_fmac_f32 v67, v14, v107
  v_fmac_f32 v68, v14, v108
  v_fmac_f32 v69, v14, v109
  v_fmac_f32 v70, v14, v110
  v_fmac_f32 v71, v14, v111
  s_lshl_b32 s97, s75, 1
  s_add_u32 s97, s97, s58
  s_lshl_b32 s97, s97, 7
  ds_read_b64_tr_b16 v[128:129], v10 offset:0
  s_lshl_b32 s98, s59, 2
  s_add_u32 s97, s97, s98
  ds_read_b64_tr_b16 v[130:131], v10 offset:1024
  s_add_u32 s97, s97, s57
  s_lshl_b32 s97, s97, 10
  ds_read_b64_tr_b16 v[132:133], v10 offset:2048
  s_add_u32 s98, s97, 0x10000
  v_mul_f32 v88, v40, v40
  ds_read_b64_tr_b16 v[134:135], v10 offset:3072
  v_mul_f32 v89, v41, v41
  v_mul_f32 v90, v42, v42
  ds_read_b64_tr_b16 v[136:137], v10 offset:4096
  v_mul_f32 v91, v43, v43
  v_fma_f32 v88, v88, v18, v17
  ds_read_b64_tr_b16 v[138:139], v10 offset:5120
  v_fma_f32 v89, v89, v18, v17
  v_fma_f32 v90, v90, v18, v17
  ds_read_b64_tr_b16 v[140:141], v10 offset:6144
  v_fma_f32 v91, v91, v18, v17
  v_mul_f32 v88, v88, v40
  ds_read_b64_tr_b16 v[142:143], v10 offset:7168
  v_mul_f32 v89, v89, v41
  v_mul_f32 v90, v90, v42
  ds_read_b64_tr_b16 v[144:145], v10 offset:16384
  v_mul_f32 v91, v91, v43
  v_exp_f32 v88, v88
  ds_read_b64_tr_b16 v[146:147], v10 offset:17408
  v_exp_f32 v89, v89
  v_exp_f32 v90, v90
  v_exp_f32 v91, v91
  ds_read_b64_tr_b16 v[148:149], v10 offset:18432
  v_mul_f32 v40, v40, v56
  v_mul_f32 v41, v41, v57
  ds_read_b64_tr_b16 v[150:151], v10 offset:19456
  v_mul_f32 v42, v42, v58
  v_mul_f32 v43, v43, v59
  ds_read_b64_tr_b16 v[152:153], v10 offset:20480
  v_fma_f32 v88, v88, v16, v16
  v_fma_f32 v89, v89, v16, v16
  ds_read_b64_tr_b16 v[154:155], v10 offset:21504
  v_fma_f32 v90, v90, v16, v16
  v_fma_f32 v91, v91, v16, v16
  ds_read_b64_tr_b16 v[156:157], v10 offset:22528
  v_rcp_f32 v88, v88
  v_rcp_f32 v89, v89
  ds_read_b64_tr_b16 v[158:159], v10 offset:23552
  v_rcp_f32 v90, v90
  v_rcp_f32 v91, v91
  ds_read_b64_tr_b16 v[160:161], v11 offset:0
  v_mul_f32 v40, v40, v88
  v_mul_f32 v41, v41, v89
  ds_read_b64_tr_b16 v[162:163], v11 offset:1024
  v_mul_f32 v42, v42, v90
  v_mul_f32 v43, v43, v91
  ds_read_b64_tr_b16 v[164:165], v11 offset:2048
  v_cvt_pk_bf16_f32 v80, v40, v41
  v_cvt_pk_bf16_f32 v81, v42, v43
  ds_read_b64_tr_b16 v[166:167], v11 offset:3072
  v_mul_f32 v88, v44, v44
  v_mul_f32 v89, v45, v45
  ds_read_b64_tr_b16 v[168:169], v11 offset:4096
  v_mul_f32 v90, v46, v46
  v_mul_f32 v91, v47, v47
  v_fma_f32 v88, v88, v18, v17
  ds_read_b64_tr_b16 v[170:171], v11 offset:5120
  v_fma_f32 v89, v89, v18, v17
  v_fma_f32 v90, v90, v18, v17
  ds_read_b64_tr_b16 v[172:173], v11 offset:6144
  v_fma_f32 v91, v91, v18, v17
  v_mul_f32 v88, v88, v44
  ds_read_b64_tr_b16 v[174:175], v11 offset:7168
  v_mul_f32 v89, v89, v45
  v_mul_f32 v90, v90, v46
  ds_read_b64_tr_b16 v[176:177], v11 offset:16384
  v_mul_f32 v91, v91, v47
  v_exp_f32 v88, v88
  ds_read_b64_tr_b16 v[178:179], v11 offset:17408
  v_exp_f32 v89, v89
  v_exp_f32 v90, v90
  ds_read_b64_tr_b16 v[180:181], v11 offset:18432
  v_exp_f32 v91, v91
  v_mul_f32 v44, v44, v60
  ds_read_b64_tr_b16 v[182:183], v11 offset:19456
  v_mul_f32 v45, v45, v61
  v_mul_f32 v46, v46, v62
  ds_read_b64_tr_b16 v[184:185], v11 offset:20480
  v_mul_f32 v47, v47, v63
  v_fma_f32 v88, v88, v16, v16
  ds_read_b64_tr_b16 v[186:187], v11 offset:21504
  v_fma_f32 v89, v89, v16, v16
  v_fma_f32 v90, v90, v16, v16
  ds_read_b64_tr_b16 v[188:189], v11 offset:22528
  v_fma_f32 v91, v91, v16, v16
  v_rcp_f32 v88, v88
  ds_read_b64_tr_b16 v[190:191], v11 offset:23552
  v_rcp_f32 v89, v89
  v_rcp_f32 v90, v90
  v_rcp_f32 v91, v91
  ds_read_b64_tr_b16 v[192:193], v10 offset:8192
  v_mul_f32 v44, v44, v88
  v_mul_f32 v45, v45, v89
  ds_read_b64_tr_b16 v[194:195], v10 offset:9216
  v_mul_f32 v46, v46, v90
  v_mul_f32 v47, v47, v91
  ds_read_b64_tr_b16 v[196:197], v10 offset:10240
  v_cvt_pk_bf16_f32 v82, v44, v45
  v_cvt_pk_bf16_f32 v83, v46, v47
  ds_read_b64_tr_b16 v[198:199], v10 offset:11264
  v_mul_f32 v88, v48, v48
  v_mul_f32 v89, v49, v49
  ds_read_b64_tr_b16 v[200:201], v10 offset:12288
  v_mul_f32 v90, v50, v50
  v_mul_f32 v91, v51, v51
  ds_read_b64_tr_b16 v[202:203], v10 offset:13312
  v_fma_f32 v88, v88, v18, v17
  v_fma_f32 v89, v89, v18, v17
  ds_read_b64_tr_b16 v[204:205], v10 offset:14336
  v_fma_f32 v90, v90, v18, v17
  v_fma_f32 v91, v91, v18, v17
  ds_read_b64_tr_b16 v[206:207], v10 offset:15360
  v_mul_f32 v88, v88, v48
  v_mul_f32 v89, v89, v49
  s_cmp_eq_u32 s56, 0
  s_cbranch_scc1 R13
B13:
  v_mul_f32 v90, v90, v50
  v_mul_f32 v91, v91, v51
  ds_read_b64_tr_b16 v[208:209], v10 offset:24576
  v_exp_f32 v88, v88
  v_exp_f32 v89, v89
  ds_read_b64_tr_b16 v[210:211], v10 offset:25600
  v_exp_f32 v90, v90
  v_exp_f32 v91, v91
  v_mul_f32 v48, v48, v64
  ds_read_b64_tr_b16 v[212:213], v10 offset:26624
  v_mul_f32 v49, v49, v65
  v_mul_f32 v50, v50, v66
  ds_read_b64_tr_b16 v[214:215], v10 offset:27648
  v_mul_f32 v51, v51, v67
  v_fma_f32 v88, v88, v16, v16
  ds_read_b64_tr_b16 v[216:217], v10 offset:28672
  v_fma_f32 v89, v89, v16, v16
  v_fma_f32 v90, v90, v16, v16
  ds_read_b64_tr_b16 v[218:219], v10 offset:29696
  v_fma_f32 v91, v91, v16, v16
  v_rcp_f32 v88, v88
  ds_read_b64_tr_b16 v[220:221], v10 offset:30720
  v_rcp_f32 v89, v89
  v_rcp_f32 v90, v90
  ds_read_b64_tr_b16 v[222:223], v10 offset:31744
  v_rcp_f32 v91, v91
  v_mul_f32 v48, v48, v88
  ds_read_b64_tr_b16 v[224:225], v11 offset:8192
  v_mul_f32 v49, v49, v89
  v_mul_f32 v50, v50, v90
  ds_read_b64_tr_b16 v[226:227], v11 offset:9216
  v_mul_f32 v51, v51, v91
  v_cvt_pk_bf16_f32 v84, v48, v49
  ds_read_b64_tr_b16 v[228:229], v11 offset:10240
  v_cvt_pk_bf16_f32 v85, v50, v51
  v_mul_f32 v88, v52, v52
  ds_read_b64_tr_b16 v[230:231], v11 offset:11264
  v_mul_f32 v89, v53, v53
  v_mul_f32 v90, v54, v54
  ds_read_b64_tr_b16 v[232:233], v11 offset:12288
  v_mul_f32 v91, v55, v55
  v_fma_f32 v88, v88, v18, v17
  v_fma_f32 v89, v89, v18, v17
  ds_read_b64_tr_b16 v[234:235], v11 offset:13312
  v_fma_f32 v90, v90, v18, v17
  v_fma_f32 v91, v91, v18, v17
  ds_read_b64_tr_b16 v[236:237], v11 offset:14336
  v_mul_f32 v88, v88, v52
  v_mul_f32 v89, v89, v53
  ds_read_b64_tr_b16 v[238:239], v11 offset:15360
  v_mul_f32 v90, v90, v54
  v_mul_f32 v91, v91, v55
  ds_read_b64_tr_b16 v[240:241], v11 offset:24576
  v_exp_f32 v88, v88
  v_exp_f32 v89, v89
  ds_read_b64_tr_b16 v[242:243], v11 offset:25600
  v_exp_f32 v90, v90
  v_exp_f32 v91, v91
  ds_read_b64_tr_b16 v[244:245], v11 offset:26624
  v_mul_f32 v52, v52, v68
  v_mul_f32 v53, v53, v69
  ds_read_b64_tr_b16 v[246:247], v11 offset:27648
  v_mul_f32 v54, v54, v70
  v_mul_f32 v55, v55, v71
  ds_read_b64_tr_b16 v[248:249], v11 offset:28672
  v_fma_f32 v88, v88, v16, v16
  v_fma_f32 v89, v89, v16, v16
  ds_read_b64_tr_b16 v[250:251], v11 offset:29696
  v_fma_f32 v90, v90, v16, v16
  v_fma_f32 v91, v91, v16, v16
  ds_read_b64_tr_b16 v[252:253], v11 offset:30720
  v_rcp_f32 v88, v88
  v_rcp_f32 v89, v89
  ds_read_b64_tr_b16 v[254:255], v11 offset:31744
  v_rcp_f32 v90, v90
  v_rcp_f32 v91, v91
  v_mul_f32 v52, v52, v88
  v_mul_f32 v53, v53, v89
  v_mul_f32 v54, v54, v90
  v_mul_f32 v55, v55, v91
  v_cvt_pk_bf16_f32 v86, v52, v53
  v_cvt_pk_bf16_f32 v87, v54, v55
  buffer_store_dwordx4 v[80:83], v72, s[48:51], s97 offen sc1
  buffer_store_dwordx4 v[84:87], v72, s[48:51], s98 offen sc1
  s_cmp_eq_u32 s56, 0
  s_cbranch_scc1 R15
B15:
  s_waitcnt lgkmcnt(0)
  s_waitcnt vmcnt(2)
  s_barrier
  ds_read_b128 v[16:19], v4 offset:8192
  ds_read_b128 v[20:23], v4 offset:1024
  v_mov_b32 v1, 0
  s_waitcnt lgkmcnt(1)
  v_dot2c_f32_bf16 v1, v76, v16
  v_dot2c_f32_bf16 v1, v77, v17
  v_dot2c_f32_bf16 v1, v78, v18
  v_dot2c_f32_bf16 v1, v79, v19
  s_nop 2
  v_mov_b32 v24, v1
  s_nop 1
  v_permlane32_swap_b32 v1, v24
  v_add_f32 v1, v1, v24
  v_sub_f32 v80, 0, v1
  v_sub_f32 v81, 0, v1
  v_sub_f32 v82, 0, v1
  v_sub_f32 v83, 0, v1
  v_sub_f32 v84, 0, v1
  v_sub_f32 v85, 0, v1
  v_sub_f32 v86, 0, v1
  v_sub_f32 v87, 0, v1
  v_sub_f32 v88, 0, v1
  v_sub_f32 v89, 0, v1
  v_sub_f32 v90, 0, v1
  v_sub_f32 v91, 0, v1
  v_sub_f32 v92, 0, v1
  v_sub_f32 v93, 0, v1
  v_sub_f32 v94, 0, v1
  v_sub_f32 v95, 0, v1
  s_cmp_gt_i32 s83, 1
  s_cbranch_scc1 R16
B16:
  s_waitcnt lgkmcnt(0)
  v_mfma_f32_32x32x16_bf16 v[56:71], v[20:23], v[76:79], v[80:95]
  ds_read_b128 v[16:19], v4 offset:2048
  s_cmp_eq_u32 s83, 2
  s_cbranch_scc1 R17
B17:
  s_waitcnt lgkmcnt(0)
  v_mfma_f32_32x32x16_bf16 v[40:55], v[16:19], v[76:79], v[80:95]
  ds_read_b128 v[20:23], v4 offset:3072
  s_nop 5
  v_exp_f32 v56, v56
  v_exp_f32 v57, v57
  v_exp_f32 v58, v58
  v_exp_f32 v59, v59
  v_exp_f32 v60, v60
  v_exp_f32 v61, v61
  v_exp_f32 v62, v62
  v_exp_f32 v63, v63
  v_exp_f32 v64, v64
  v_exp_f32 v65, v65
  v_exp_f32 v66, v66
  v_exp_f32 v67, v67
  v_add_u32 v5, v5, v6
  v_exp_f32 v68, v68
  ds_read_b64_tr_b16 v[24:25], v5 offset:0
  v_exp_f32 v69, v69
  ds_read_b64_tr_b16 v[26:27], v5 offset:256
  v_exp_f32 v70, v70
  ds_read_b64_tr_b16 v[28:29], v5 offset:512
  v_exp_f32 v71, v71
  ds_read_b64_tr_b16 v[30:31], v5 offset:768
  v_cvt_pk_bf16_f32 v8, v56, v57
  v_cvt_pk_bf16_f32 v9, v58, v59
  v_cvt_pk_bf16_f32 v10, v60, v61
  v_cvt_pk_bf16_f32 v11, v62, v63
  v_cvt_pk_bf16_f32 v12, v64, v65
  v_cvt_pk_bf16_f32 v13, v66, v67
  v_cvt_pk_bf16_f32 v14, v68, v69
  v_cvt_pk_bf16_f32 v15, v70, v71
  s_cmp_eq_u32 s83, 3
  s_cbranch_scc1 R18
B18:
  s_waitcnt lgkmcnt(4)
  v_mfma_f32_32x32x16_bf16 v[56:71], v[20:23], v[76:79], v[80:95]
  ds_read_b128 v[16:19], v4 offset:4096
  v_exp_f32 v40, v40
  v_exp_f32 v41, v41
  v_exp_f32 v42, v42
  v_exp_f32 v43, v43
  v_exp_f32 v44, v44
  s_waitcnt lgkmcnt(1)
  v_mfma_f32_32x32x16_bf16 v[96:111], v[24:27], v[8:11], 0
  v_exp_f32 v45, v45
  v_exp_f32 v46, v46
  v_exp_f32 v47, v47
  v_exp_f32 v48, v48
  v_exp_f32 v49, v49
  v_mfma_f32_32x32x16_bf16 v[96:111], v[28:31], v[12:15], v[96:111]
  v_exp_f32 v50, v50
  v_exp_f32 v51, v51
  v_add_u32 v5, v5, v6
  v_exp_f32 v52, v52
  ds_read_b64_tr_b16 v[24:25], v5 offset:0
  v_exp_f32 v53, v53
  ds_read_b64_tr_b16 v[26:27], v5 offset:256
  v_exp_f32 v54, v54
  ds_read_b64_tr_b16 v[28:29], v5 offset:512
  v_exp_f32 v55, v55
  ds_read_b64_tr_b16 v[30:31], v5 offset:768
  v_cvt_pk_bf16_f32 v32, v40, v41
  v_cvt_pk_bf16_f32 v33, v42, v43
  v_cvt_pk_bf16_f32 v34, v44, v45
  v_cvt_pk_bf16_f32 v35, v46, v47
  v_cvt_pk_bf16_f32 v36, v48, v49
  v_cvt_pk_bf16_f32 v37, v50, v51
  v_cvt_pk_bf16_f32 v38, v52, v53
  v_cvt_pk_bf16_f32 v39, v54, v55
  s_cmp_eq_u32 s83, 4
  s_cbranch_scc1 R19
B19:
  s_waitcnt lgkmcnt(4)
  v_mfma_f32_32x32x16_bf16 v[40:55], v[16:19], v[76:79], v[80:95]
  ds_read_b128 v[20:23], v4 offset:5120
  v_exp_f32 v56, v56
  v_exp_f32 v57, v57
  v_exp_f32 v58, v58
  v_exp_f32 v59, v59
  v_exp_f32 v60, v60
  s_waitcnt lgkmcnt(1)
  v_mfma_f32_32x32x16_bf16 v[96:111], v[24:27], v[32:35], v[96:111]
  v_exp_f32 v61, v61
  v_exp_f32 v62, v62
  v_exp_f32 v63, v63
  v_exp_f32 v64, v64
  v_exp_f32 v65, v65
  v_mfma_f32_32x32x16_bf16 v[96:111], v[28:31], v[36:39], v[96:111]
  v_exp_f32 v66, v66
  v_exp_f32 v67, v67
  v_add_u32 v5, v5, v6
  v_exp_f32 v68, v68
  ds_read_b64_tr_b16 v[24:25], v5 offset:0
  v_exp_f32 v69, v69
  ds_read_b64_tr_b16 v[26:27], v5 offset:256
  v_exp_f32 v70, v70
  ds_read_b64_tr_b16 v[28:29], v5 offset:512
  v_exp_f32 v71, v71
  ds_read_b64_tr_b16 v[30:31], v5 offset:768
  v_cvt_pk_bf16_f32 v8, v56, v57
  v_cvt_pk_bf16_f32 v9, v58, v59
  v_cvt_pk_bf16_f32 v10, v60, v61
  v_cvt_pk_bf16_f32 v11, v62, v63
  v_cvt_pk_bf16_f32 v12, v64, v65
  v_cvt_pk_bf16_f32 v13, v66, v67
  v_cvt_pk_bf16_f32 v14, v68, v69
  v_cvt_pk_bf16_f32 v15, v70, v71
  s_cmp_eq_u32 s83, 5
  s_cbranch_scc1 R20
B20:
  s_waitcnt lgkmcnt(4)
  v_mfma_f32_32x32x16_bf16 v[56:71], v[20:23], v[76:79], v[80:95]
  ds_read_b128 v[16:19], v4 offset:6144
  v_exp_f32 v40, v40
  v_exp_f32 v41, v41
  v_exp_f32 v42, v42
  v_exp_f32 v43, v43
  v_exp_f32 v44, v44
  s_waitcnt lgkmcnt(1)
  v_mfma_f32_32x32x16_bf16 v[96:111], v[24:27], v[8:11], v[96:111]
  v_exp_f32 v45, v45
  v_exp_f32 v46, v46
  s_waitcnt vmcnt(0)
  s_barrier
  s_cmp_eq_u32 s56, 0
  s_cbranch_scc1 R21
B21:
  v_exp_f32 v47, v47
  v_exp_f32 v48, v48
  v_exp_f32 v49, v49
  v_mfma_f32_32x32x16_bf16 v[96:111], v[28:31], v[12:15], v[96:111]
  v_exp_f32 v50, v50
  v_exp_f32 v51, v51
  v_add_u32 v5, v5, v6
  v_exp_f32 v52, v52
  ds_read_b64_tr_b16 v[24:25], v5 offset:0
  v_exp_f32 v53, v53
  ds_read_b64_tr_b16 v[26:27], v5 offset:256
  v_exp_f32 v54, v54
  ds_read_b64_tr_b16 v[28:29], v5 offset:512
  v_exp_f32 v55, v55
  ds_read_b64_tr_b16 v[30:31], v5 offset:768
  v_cvt_pk_bf16_f32 v32, v40, v41
  v_cvt_pk_bf16_f32 v33, v42, v43
  v_cvt_pk_bf16_f32 v34, v44, v45
  v_cvt_pk_bf16_f32 v35, v46, v47
  v_cvt_pk_bf16_f32 v36, v48, v49
  v_cvt_pk_bf16_f32 v37, v50, v51
  v_cvt_pk_bf16_f32 v38, v52, v53
  v_cvt_pk_bf16_f32 v39, v54, v55
  s_cmp_eq_u32 s83, 6
  s_cbranch_scc1 R22
B22:
  s_waitcnt lgkmcnt(4)
  v_mfma_f32_32x32x16_bf16 v[40:55], v[16:19], v[76:79], v[80:95]
  ds_read_b128 v[20:23], v4 offset:7168
  v_exp_f32 v56, v56
  v_exp_f32 v57, v57
  v_exp_f32 v58, v58
  v_exp_f32 v59, v59
  v_exp_f32 v60, v60
  s_waitcnt lgkmcnt(1)
  v_mfma_f32_32x32x16_bf16 v[96:111], v[24:27], v[32:35], v[96:111]
  v_exp_f32 v61, v61
  v_exp_f32 v62, v62
  v_exp_f32 v63, v63
  v_exp_f32 v64, v64
  v_exp_f32 v65, v65
  v_mfma_f32_32x32x16_bf16 v[96:111], v[28:31], v[36:39], v[96:111]
  v_exp_f32 v66, v66
  v_exp_f32 v67, v67
  v_add_u32 v5, v5, v6
  v_exp_f32 v68, v68
  ds_read_b64_tr_b16 v[24:25], v5 offset:0
  v_exp_f32 v69, v69
  ds_read_b64_tr_b16 v[26:27], v5 offset:256
  v_exp_f32 v70, v70
  ds_read_b64_tr_b16 v[28:29], v5 offset:512
  v_exp_f32 v71, v71
  ds_read_b64_tr_b16 v[30:31], v5 offset:768
  v_cvt_pk_bf16_f32 v8, v56, v57
  v_cvt_pk_bf16_f32 v9, v58, v59
  v_cvt_pk_bf16_f32 v10, v60, v61
  v_cvt_pk_bf16_f32 v11, v62, v63
  v_cvt_pk_bf16_f32 v12, v64, v65
  v_cvt_pk_bf16_f32 v13, v66, v67
  v_cvt_pk_bf16_f32 v14, v68, v69
  v_cvt_pk_bf16_f32 v15, v70, v71
  s_cmp_eq_u32 s83, 7
  s_cbranch_scc1 R23
B23:
  s_waitcnt lgkmcnt(4)
  v_mfma_f32_32x32x16_bf16 v[56:71], v[20:23], v[76:79], v[80:95]
  ds_read_b128 v[16:19], v4 offset:8192
  v_exp_f32 v40, v40
  v_exp_f32 v41, v41
  v_exp_f32 v42, v42
  v_exp_f32 v43, v43
  v_exp_f32 v44, v44
  s_waitcnt lgkmcnt(1)
  v_mfma_f32_32x32x16_bf16 v[96:111], v[24:27], v[8:11], v[96:111]
  v_exp_f32 v45, v45
  v_exp_f32 v46, v46
  v_exp_f32 v47, v47
  v_exp_f32 v48, v48
  v_exp_f32 v49, v49
  s_barrier
  v_mfma_f32_32x32x16_bf16 v[96:111], v[28:31], v[12:15], v[96:111]
  v_exp_f32 v50, v50
  v_exp_f32 v51, v51
  v_add_u32 v5, v5, v6
  v_exp_f32 v52, v52
  ds_read_b64_tr_b16 v[24:25], v5 offset:0
  v_exp_f32 v53, v53
  ds_read_b64_tr_b16 v[26:27], v5 offset:256
  v_exp_f32 v54, v54
  ds_read_b64_tr_b16 v[28:29], v5 offset:512
  v_exp_f32 v55, v55
  ds_read_b64_tr_b16 v[30:31], v5 offset:768
  v_cvt_pk_bf16_f32 v32, v40, v41
  v_cvt_pk_bf16_f32 v33, v42, v43
  v_cvt_pk_bf16_f32 v34, v44, v45
  v_cvt_pk_bf16_f32 v35, v46, v47
  v_cvt_pk_bf16_f32 v36, v48, v49
  v_cvt_pk_bf16_f32 v37, v50, v51
  v_cvt_pk_bf16_f32 v38, v52, v53
  v_cvt_pk_bf16_f32 v39, v54, v55
  s_cmp_eq_u32 s83, 8
  s_cbranch_scc1 R24
B24:
  s_waitcnt lgkmcnt(4)
  v_mfma_f32_32x32x16_bf16 v[40:55], v[16:19], v[76:79], v[80:95]
  ds_read_b128 v[20:23], v4 offset:0
  v_exp_f32 v56, v56
  v_exp_f32 v57, v57
  v_exp_f32 v58, v58
  v_exp_f32 v59, v59
  v_exp_f32 v60, v60
  s_waitcnt lgkmcnt(1)
  v_mfma_f32_32x32x16_bf16 v[96:111], v[24:27], v[32:35], v[96:111]
  v_exp_f32 v61, v61
  v_exp_f32 v62, v62
  v_exp_f32 v63, v63
  v_exp_f32 v64, v64
  v_exp_f32 v65, v65
  v_mfma_f32_32x32x16_bf16 v[96:111], v[28:31], v[36:39], v[96:111]
  v_exp_f32 v66, v66
  v_exp_f32 v67, v67
  v_add_u32 v5, v5, v6
  v_exp_f32 v68, v68
  ds_read_b64_tr_b16 v[24:25], v5 offset:0
  v_exp_f32 v69, v69
  ds_read_b64_tr_b16 v[26:27], v5 offset:256
  v_exp_f32 v70, v70
  ds_read_b64_tr_b16 v[28:29], v5 offset:512
  v_exp_f32 v71, v71
  ds_read_b64_tr_b16 v[30:31], v5 offset:768
  v_cvt_pk_bf16_f32 v8, v56, v57
  v_cvt_pk_bf16_f32 v9, v58, v59
  v_cvt_pk_bf16_f32 v10, v60, v61
  v_cvt_pk_bf16_f32 v11, v62, v63
  v_cvt_pk_bf16_f32 v12, v64, v65
  v_cvt_pk_bf16_f32 v13, v66, v67
  v_cvt_pk_bf16_f32 v14, v68, v69
  v_cvt_pk_bf16_f32 v15, v70, v71
  s_waitcnt lgkmcnt(4)
  v_mfma_f32_32x32x16_bf16 v[56:71], v[20:23], v[76:79], v[80:95]
  s_cmp_gt_i32 s83, 0
  s_cbranch_scc1 R25
B25:
  s_waitcnt lgkmcnt(0)
  v_mfma_f32_32x32x16_bf16 v[96:111], v[24:27], v[8:11], v[96:111]
  v_mfma_f32_32x32x16_bf16 v[96:111], v[28:31], v[12:15], v[96:111]
  s_nop 6
  v_cndmask_b32 v40, v56, v40, s[4:5]
  v_cndmask_b32 v41, v57, v41, s[6:7]
  v_cndmask_b32 v42, v58, v42, s[8:9]
  v_cndmask_b32 v43, v59, v43, s[10:11]
  v_cndmask_b32 v44, v60, v44, s[12:13]
  v_cndmask_b32 v45, v61, v45, s[14:15]
  v_cndmask_b32 v46, v62, v46, s[16:17]
  v_cndmask_b32 v47, v63, v47, s[18:19]
  v_cndmask_b32 v48, v64, v48, s[20:21]
  v_cndmask_b32 v49, v65, v49, s[22:23]
  v_cndmask_b32 v50, v66, v50, s[40:41]
  v_cndmask_b32 v51, v67, v51, s[42:43]
  v_cndmask_b32 v52, v68, v52, s[44:45]
  v_cndmask_b32 v53, v69, v53, s[46:47]
  v_cndmask_b32 v54, v70, v54, s[64:65]
  v_cndmask_b32 v55, v71, v55, s[66:67]
  v_add_u32 v5, v5, v6
  ds_read_b64_tr_b16 v[24:25], v5 offset:0
  ds_read_b64_tr_b16 v[26:27], v5 offset:256
  ds_read_b64_tr_b16 v[28:29], v5 offset:512
  ds_read_b64_tr_b16 v[30:31], v5 offset:768
  v_exp_f32 v40, v40
  v_exp_f32 v41, v41
  v_exp_f32 v42, v42
  v_exp_f32 v43, v43
  s_barrier
  v_exp_f32 v44, v44
  v_exp_f32 v45, v45
  v_exp_f32 v46, v46
  v_exp_f32 v47, v47
  v_exp_f32 v48, v48
  v_exp_f32 v49, v49
  v_exp_f32 v50, v50
  v_exp_f32 v51, v51
  v_exp_f32 v52, v52
  v_exp_f32 v53, v53
  v_exp_f32 v54, v54
  v_exp_f32 v55, v55
  v_cndmask_b32 v56, 0, v40, s[4:5]
  v_cndmask_b32 v57, 0, v41, s[6:7]
  v_cndmask_b32 v58, 0, v42, s[8:9]
  v_cndmask_b32 v59, 0, v43, s[10:11]
  v_cndmask_b32 v60, 0, v44, s[12:13]
  v_cndmask_b32 v61, 0, v45, s[14:15]
  v_cndmask_b32 v62, 0, v46, s[16:17]
  v_cndmask_b32 v63, 0, v47, s[18:19]
  v_cndmask_b32 v64, 0, v48, s[20:21]
  v_cndmask_b32 v65, 0, v49, s[22:23]
  v_cndmask_b32 v66, 0, v50, s[40:41]
  v_cndmask_b32 v67, 0, v51, s[42:43]
  v_cndmask_b32 v68, 0, v52, s[44:45]
  v_cndmask_b32 v69, 0, v53, s[46:47]
  v_cndmask_b32 v70, 0, v54, s[64:65]
  v_cndmask_b32 v71, 0, v55, s[66:67]
  v_cvt_pk_bf16_f32 v32, v56, v57
  v_cvt_pk_bf16_f32 v33, v58, v59
  v_cvt_pk_bf16_f32 v34, v60, v61
  v_cvt_pk_bf16_f32 v35, v62, v63
  v_cvt_pk_bf16_f32 v36, v64, v65
  v_cvt_pk_bf16_f32 v37, v66, v67
  v_cvt_pk_bf16_f32 v38, v68, v69
  v_cvt_pk_bf16_f32 v39, v70, v71
  s_waitcnt lgkmcnt(0)
  v_mfma_f32_32x32x16_bf16 v[96:111], v[24:27], v[32:35], v[96:111]
  v_cndmask_b32 v40, v40, 0, s[4:5]
  v_cndmask_b32 v41, v41, 0, s[6:7]
  v_cndmask_b32 v42, v42, 0, s[8:9]
  v_cndmask_b32 v43, v43, 0, s[10:11]
  v_cndmask_b32 v44, v44, 0, s[12:13]
  v_cndmask_b32 v45, v45, 0, s[14:15]
  v_cndmask_b32 v46, v46, 0, s[16:17]
  v_cndmask_b32 v47, v47, 0, s[18:19]
  v_mfma_f32_32x32x16_bf16 v[96:111], v[28:31], v[36:39], v[96:111]
  v_lshlrev_b32 v16, 3, v6
  v_sub_u32 v5, v5, v16
  ds_read_b64_tr_b16 v[24:25], v5 offset:0
  ds_read_b64_tr_b16 v[26:27], v5 offset:256
  ds_read_b64_tr_b16 v[28:29], v5 offset:512
  ds_read_b64_tr_b16 v[30:31], v5 offset:768
  v_cndmask_b32 v48, v48, 0, s[20:21]
  v_cndmask_b32 v49, v49, 0, s[22:23]
  v_cndmask_b32 v50, v50, 0, s[40:41]
  v_cndmask_b32 v51, v51, 0, s[42:43]
  v_cndmask_b32 v52, v52, 0, s[44:45]
  v_cndmask_b32 v53, v53, 0, s[46:47]
  v_cndmask_b32 v54, v54, 0, s[64:65]
  v_cndmask_b32 v55, v55, 0, s[66:67]
  v_cvt_pk_bf16_f32 v8, v40, v41
  v_cvt_pk_bf16_f32 v9, v42, v43
  v_cvt_pk_bf16_f32 v10, v44, v45
  v_cvt_pk_bf16_f32 v11, v46, v47
  v_cvt_pk_bf16_f32 v12, v48, v49
  v_cvt_pk_bf16_f32 v13, v50, v51
  v_cvt_pk_bf16_f32 v14, v52, v53
  v_cvt_pk_bf16_f32 v15, v54, v55
  s_waitcnt lgkmcnt(0)
  v_mfma_f32_32x32x16_bf16 v[96:111], v[24:27], v[8:11], v[96:111]
  v_mfma_f32_32x32x16_bf16 v[96:111], v[28:31], v[12:15], v[96:111]
  s_lshl_b32 s97, s81, 16
  s_lshl_b32 s98, s82, 13
  s_add_u32 s97, s97, s98
  s_add_u32 s97, s97, s90
  s_add_u32 s97, s97, 7340032
  s_mov_b32 s98, 0
  s_nop 5
  v_cmp_nlt_f32 vcc, v104, v7
  s_nop 4
  s_cbranch_vccnz L_fb
L_fbd0:
  v_rcp_f32 v1, v104
  s_nop 0
  v_mul_f32 v96, v96, v1
  v_mul_f32 v97, v97, v1
  v_mul_f32 v98, v98, v1
  v_mul_f32 v99, v99, v1
  v_mul_f32 v100, v100, v1
  v_mul_f32 v101, v101, v1
  v_mul_f32 v102, v102, v1
  v_mul_f32 v103, v103, v1
  v_cvt_pk_bf16_f32 v56, v96, v97
  v_cvt_pk_bf16_f32 v57, v98, v99
  v_cvt_pk_bf16_f32 v58, v100, v101
  v_cvt_pk_bf16_f32 v59, v102, v103
  buffer_store_dwordx4 v[56:59], v72, s[48:51], s97 offen sc1
  v_mov_b32 v76, v112
  v_mov_b32 v77, v113
  v_mov_b32 v78, v114
  v_mov_b32 v79, v115
  v_add_u32 v4, 0x400, v4
  v_add_u32 v5, v5, v6
  s_sub_i32 s83, s83, 1
  ds_read_b128 v[16:19], v4 offset:8192
  ds_read_b128 v[20:23], v4 offset:1024
  v_mov_b32 v1, 0
  s_waitcnt lgkmcnt(1)
  v_dot2c_f32_bf16 v1, v76, v16
  v_dot2c_f32_bf16 v1, v77, v17
  v_dot2c_f32_bf16 v1, v78, v18
  v_dot2c_f32_bf16 v1, v79, v19
  s_nop 2
  v_mov_b32 v24, v1
  s_nop 1
  v_permlane32_swap_b32 v1, v24
  v_add_f32 v1, v1, v24
  v_sub_f32 v80, 0, v1
  v_sub_f32 v81, 0, v1
  v_sub_f32 v82, 0, v1
  v_sub_f32 v83, 0, v1
  v_sub_f32 v84, 0, v1
  v_sub_f32 v85, 0, v1
  v_sub_f32 v86, 0, v1
  v_sub_f32 v87, 0, v1
  v_sub_f32 v88, 0, v1
  v_sub_f32 v89, 0, v1
  v_sub_f32 v90, 0, v1
  v_sub_f32 v91, 0, v1
  v_sub_f32 v92, 0, v1
  s_barrier
  s_add_u32 s76, s76, 4096
  s_cmp_eq_u32 s56, 0
  s_cbranch_scc1 R26
B26:
  v_sub_f32 v93, 0, v1
  v_sub_f32 v94, 0, v1
  v_sub_f32 v95, 0, v1
  s_cmp_gt_i32 s83, 1
  s_cbranch_scc1 R27
B27:
  s_waitcnt lgkmcnt(0)
  v_mfma_f32_32x32x16_bf16 v[56:71], v[20:23], v[76:79], v[80:95]
  ds_read_b128 v[16:19], v4 offset:2048
  s_cmp_eq_u32 s83, 2
  s_cbranch_scc1 R28
B28:
  s_waitcnt lgkmcnt(0)
  v_mfma_f32_32x32x16_bf16 v[40:55], v[16:19], v[76:79], v[80:95]
  ds_read_b128 v[20:23], v4 offset:3072
  s_nop 5
  v_exp_f32 v56, v56
  v_exp_f32 v57, v57
  v_exp_f32 v58, v58
  v_exp_f32 v59, v59
  v_exp_f32 v60, v60
  v_exp_f32 v61, v61
  v_exp_f32 v62, v62
  v_exp_f32 v63, v63
  v_exp_f32 v64, v64
  v_exp_f32 v65, v65
  v_exp_f32 v66, v66
  v_exp_f32 v67, v67
  v_add_u32 v5, v5, v6
  v_exp_f32 v68, v68
  ds_read_b64_tr_b16 v[24:25], v5 offset:0
  v_exp_f32 v69, v69
  ds_read_b64_tr_b16 v[26:27], v5 offset:256
  v_exp_f32 v70, v70
  ds_read_b64_tr_b16 v[28:29], v5 offset:512
  v_exp_f32 v71, v71
  ds_read_b64_tr_b16 v[30:31], v5 offset:768
  v_cvt_pk_bf16_f32 v8, v56, v57
  v_cvt_pk_bf16_f32 v9, v58, v59
  v_cvt_pk_bf16_f32 v10, v60, v61
  v_cvt_pk_bf16_f32 v11, v62, v63
  v_cvt_pk_bf16_f32 v12, v64, v65
  v_cvt_pk_bf16_f32 v13, v66, v67
  v_cvt_pk_bf16_f32 v14, v68, v69
  v_cvt_pk_bf16_f32 v15, v70, v71
  s_cmp_eq_u32 s83, 3
  s_cbranch_scc1 R29
B29:
  s_waitcnt lgkmcnt(4)
  v_mfma_f32_32x32x16_bf16 v[56:71], v[20:23], v[76:79], v[80:95]
  ds_read_b128 v[16:19], v4 offset:4096
  v_exp_f32 v40, v40
  v_exp_f32 v41, v41
  v_exp_f32 v42, v42
  v_exp_f32 v43, v43
  v_exp_f32 v44, v44
  s_waitcnt lgkmcnt(1)
  v_mfma_f32_32x32x16_bf16 v[96:111], v[24:27], v[8:11], 0
  v_exp_f32 v45, v45
  v_exp_f32 v46, v46
  v_exp_f32 v47, v47
  v_exp_f32 v48, v48
  v_exp_f32 v49, v49
  v_mfma_f32_32x32x16_bf16 v[96:111], v[28:31], v[12:15], v[96:111]
  v_exp_f32 v50, v50
  v_exp_f32 v51, v51
  v_add_u32 v5, v5, v6
  v_exp_f32 v52, v52
  ds_read_b64_tr_b16 v[24:25], v5 offset:0
  v_exp_f32 v53, v53
  ds_read_b64_tr_b16 v[26:27], v5 offset:256
  v_exp_f32 v54, v54
  ds_read_b64_tr_b16 v[28:29], v5 offset:512
  v_exp_f32 v55, v55
  ds_read_b64_tr_b16 v[30:31], v5 offset:768
  v_cvt_pk_bf16_f32 v32, v40, v41
  v_cvt_pk_bf16_f32 v33, v42, v43
  v_cvt_pk_bf16_f32 v34, v44, v45
  v_cvt_pk_bf16_f32 v35, v46, v47
  v_cvt_pk_bf16_f32 v36, v48, v49
  v_cvt_pk_bf16_f32 v37, v50, v51
  v_cvt_pk_bf16_f32 v38, v52, v53
  v_cvt_pk_bf16_f32 v39, v54, v55
  s_cmp_eq_u32 s83, 4
  s_cbranch_scc1 R30
B30:
  s_waitcnt lgkmcnt(4)
  v_mfma_f32_32x32x16_bf16 v[40:55], v[16:19], v[76:79], v[80:95]
  ds_read_b128 v[20:23], v4 offset:5120
  v_exp_f32 v56, v56
  s_cmp_eq_u32 s56, 0
  s_cbranch_scc1 R32
B32:
  s_barrier
  v_exp_f32 v57, v57
  v_exp_f32 v58, v58
  v_exp_f32 v59, v59
  v_exp_f32 v60, v60
  s_waitcnt lgkmcnt(1)
  v_mfma_f32_32x32x16_bf16 v[96:111], v[24:27], v[32:35], v[96:111]
  v_exp_f32 v61, v61
  v_exp_f32 v62, v62
  v_exp_f32 v63, v63
  v_exp_f32 v64, v64
  v_exp_f32 v65, v65
  v_mfma_f32_32x32x16_bf16 v[96:111], v[28:31], v[36:39], v[96:111]
  v_exp_f32 v66, v66
  v_exp_f32 v67, v67
  v_add_u32 v5, v5, v6
  v_exp_f32 v68, v68
  ds_read_b64_tr_b16 v[24:25], v5 offset:0
  v_exp_f32 v69, v69
  ds_read_b64_tr_b16 v[26:27], v5 offset:256
  v_exp_f32 v70, v70
  ds_read_b64_tr_b16 v[28:29], v5 offset:512
  v_exp_f32 v71, v71
  ds_read_b64_tr_b16 v[30:31], v5 offset:768
  v_cvt_pk_bf16_f32 v8, v56, v57
  v_cvt_pk_bf16_f32 v9, v58, v59
  v_cvt_pk_bf16_f32 v10, v60, v61
  v_cvt_pk_bf16_f32 v11, v62, v63
  v_cvt_pk_bf16_f32 v12, v64, v65
  v_cvt_pk_bf16_f32 v13, v66, v67
  v_cvt_pk_bf16_f32 v14, v68, v69
  v_cvt_pk_bf16_f32 v15, v70, v71
  s_cmp_eq_u32 s83, 5
  s_cbranch_scc1 R33
B33:
  s_waitcnt lgkmcnt(4)
  v_mfma_f32_32x32x16_bf16 v[56:71], v[20:23], v[76:79], v[80:95]
  ds_read_b128 v[16:19], v4 offset:6144
  v_exp_f32 v40, v40
  v_exp_f32 v41, v41
  v_exp_f32 v42, v42
  v_exp_f32 v43, v43
  v_exp_f32 v44, v44
  s_waitcnt lgkmcnt(1)
  v_mfma_f32_32x32x16_bf16 v[96:111], v[24:27], v[8:11], v[96:111]
  v_exp_f32 v45, v45
  v_exp_f32 v46, v46
  v_exp_f32 v47, v47
  v_exp_f32 v48, v48
  v_exp_f32 v49, v49
  v_mfma_f32_32x32x16_bf16 v[96:111], v[28:31], v[12:15], v[96:111]
  v_exp_f32 v50, v50
  v_exp_f32 v51, v51
  v_add_u32 v5, v5, v6
  v_exp_f32 v52, v52
  ds_read_b64_tr_b16 v[24:25], v5 offset:0
  v_exp_f32 v53, v53
  ds_read_b64_tr_b16 v[26:27], v5 offset:256
  v_exp_f32 v54, v54
  ds_read_b64_tr_b16 v[28:29], v5 offset:512
  v_exp_f32 v55, v55
  ds_read_b64_tr_b16 v[30:31], v5 offset:768
  v_cvt_pk_bf16_f32 v32, v40, v41
  v_cvt_pk_bf16_f32 v33, v42, v43
  v_cvt_pk_bf16_f32 v34, v44, v45
  v_cvt_pk_bf16_f32 v35, v46, v47
  v_cvt_pk_bf16_f32 v36, v48, v49
  v_cvt_pk_bf16_f32 v37, v50, v51
  v_cvt_pk_bf16_f32 v38, v52, v53
  v_cvt_pk_bf16_f32 v39, v54, v55
  s_cmp_eq_u32 s83, 6
  s_cbranch_scc1 R34
B34:
  s_waitcnt lgkmcnt(4)
  v_mfma_f32_32x32x16_bf16 v[40:55], v[16:19], v[76:79], v[80:95]
  ds_read_b128 v[20:23], v4 offset:7168
  v_exp_f32 v56, v56
  v_exp_f32 v57, v57
  v_exp_f32 v58, v58
  v_exp_f32 v59, v59
  s_barrier
  v_exp_f32 v60, v60
  s_waitcnt lgkmcnt(1)
  v_mfma_f32_32x32x16_bf16 v[96:111], v[24:27], v[32:35], v[96:111]
  v_exp_f32 v61, v61
  v_exp_f32 v62, v62
  v_exp_f32 v63, v63
  v_exp_f32 v64, v64
  v_exp_f32 v65, v65
  v_mfma_f32_32x32x16_bf16 v[96:111], v[28:31], v[36:39], v[96:111]
  v_exp_f32 v66, v66
  v_exp_f32 v67, v67
  v_add_u32 v5, v5, v6
  v_exp_f32 v68, v68
  ds_read_b64_tr_b16 v[24:25], v5 offset:0
  v_exp_f32 v69, v69
  ds_read_b64_tr_b16 v[26:27], v5 offset:256
  v_exp_f32 v70, v70
  ds_read_b64_tr_b16 v[28:29], v5 offset:512
  v_exp_f32 v71, v71
  ds_read_b64_tr_b16 v[30:31], v5 offset:768
  v_cvt_pk_bf16_f32 v8, v56, v57
  v_cvt_pk_bf16_f32 v9, v58, v59
  v_cvt_pk_bf16_f32 v10, v60, v61
  v_cvt_pk_bf16_f32 v11, v62, v63
  v_cvt_pk_bf16_f32 v12, v64, v65
  v_cvt_pk_bf16_f32 v13, v66, v67
  v_cvt_pk_bf16_f32 v14, v68, v69
  v_cvt_pk_bf16_f32 v15, v70, v71
  s_cmp_eq_u32 s83, 7
  s_cbranch_scc1 R35
B35:
  s_waitcnt lgkmcnt(4)
  v_mfma_f32_32x32x16_bf16 v[56:71], v[20:23], v[76:79], v[80:95]
  ds_read_b128 v[16:19], v4 offset:8192
  v_exp_f32 v40, v40
  v_exp_f32 v41, v41
  v_exp_f32 v42, v42
  v_exp_f32 v43, v43
  v_exp_f32 v44, v44
  s_waitcnt lgkmcnt(1)
  v_mfma_f32_32x32x16_bf16 v[96:111], v[24:27], v[8:11], v[96:111]
  v_exp_f32 v45, v45
  v_exp_f32 v46, v46
  v_exp_f32 v47, v47
  v_exp_f32 v48, v48
  v_exp_f32 v49, v49
  v_mfma_f32_32x32x16_bf16 v[96:111], v[28:31], v[12:15], v[96:111]
  v_exp_f32 v50, v50
  v_exp_f32 v51, v51
  v_add_u32 v5, v5, v6
  v_exp_f32 v52, v52
  ds_read_b64_tr_b16 v[24:25], v5 offset:0
  v_exp_f32 v53, v53
  ds_read_b64_tr_b16 v[26:27], v5 offset:256
  v_exp_f32 v54, v54
  ds_read_b64_tr_b16 v[28:29], v5 offset:512
  v_exp_f32 v55, v55
  ds_read_b64_tr_b16 v[30:31], v5 offset:768
  v_cvt_pk_bf16_f32 v32, v40, v41
  v_cvt_pk_bf16_f32 v33, v42, v43
  v_cvt_pk_bf16_f32 v34, v44, v45
  v_cvt_pk_bf16_f32 v35, v46, v47
  v_cvt_pk_bf16_f32 v36, v48, v49
  v_cvt_pk_bf16_f32 v37, v50, v51
  v_cvt_pk_bf16_f32 v38, v52, v53
  v_cvt_pk_bf16_f32 v39, v54, v55
  s_cmp_eq_u32 s83, 8
  s_cbranch_scc1 R36
B36:
  s_waitcnt lgkmcnt(4)
  v_mfma_f32_32x32x16_bf16 v[40:55], v[16:19], v[76:79], v[80:95]
  ds_read_b128 v[20:23], v4 offset:0
  v_exp_f32 v56, v56
  v_exp_f32 v57, v57
  v_exp_f32 v58, v58
  v_exp_f32 v59, v59
  v_exp_f32 v60, v60
  s_waitcnt lgkmcnt(1)
  v_mfma_f32_32x32x16_bf16 v[96:111], v[24:27], v[32:35], v[96:111]
  v_exp_f32 v61, v61
  s_barrier
  v_exp_f32 v62, v62
  v_exp_f32 v63, v63
  v_exp_f32 v64, v64
  v_exp_f32 v65, v65
  v_mfma_f32_32x32x16_bf16 v[96:111], v[28:31], v[36:39], v[96:111]
  v_exp_f32 v66, v66
  v_exp_f32 v67, v67
  v_add_u32 v5, v5, v6
  v_exp_f32 v68, v68
  ds_read_b64_tr_b16 v[24:25], v5 offset:0
  v_exp_f32 v69, v69
  ds_read_b64_tr_b16 v[26:27], v5 offset:256
  v_exp_f32 v70, v70
  ds_read_b64_tr_b16 v[28:29], v5 offset:512
  v_exp_f32 v71, v71
  ds_read_b64_tr_b16 v[30:31], v5 offset:768
  v_cvt_pk_bf16_f32 v8, v56, v57
  v_cvt_pk_bf16_f32 v9, v58, v59
  v_cvt_pk_bf16_f32 v10, v60, v61
  v_cvt_pk_bf16_f32 v11, v62, v63
  v_cvt_pk_bf16_f32 v12, v64, v65
  v_cvt_pk_bf16_f32 v13, v66, v67
  v_cvt_pk_bf16_f32 v14, v68, v69
  v_cvt_pk_bf16_f32 v15, v70, v71
  s_waitcnt lgkmcnt(4)
  v_mfma_f32_32x32x16_bf16 v[56:71], v[20:23], v[76:79], v[80:95]
  s_cmp_gt_i32 s83, 0
  s_cbranch_scc1 R37
B37:
  s_waitcnt lgkmcnt(0)
  v_mfma_f32_32x32x16_bf16 v[96:111], v[24:27], v[8:11], v[96:111]
  v_mfma_f32_32x32x16_bf16 v[96:111], v[28:31], v[12:15], v[96:111]
  s_nop 6
  v_cndmask_b32 v40, v56, v40, s[4:5]
  v_cndmask_b32 v41, v57, v41, s[6:7]
  v_cndmask_b32 v42, v58, v42, s[8:9]
  v_cndmask_b32 v43, v59, v43, s[10:11]
  v_cndmask_b32 v44, v60, v44, s[12:13]
  v_cndmask_b32 v45, v61, v45, s[14:15]
  v_cndmask_b32 v46, v62, v46, s[16:17]
  v_cndmask_b32 v47, v63, v47, s[18:19]
  v_cndmask_b32 v48, v64, v48, s[20:21]
  v_cndmask_b32 v49, v65, v49, s[22:23]
  v_cndmask_b32 v50, v66, v50, s[40:41]
  v_cndmask_b32 v51, v67, v51, s[42:43]
  v_cndmask_b32 v52, v68, v52, s[44:45]
  v_cndmask_b32 v53, v69, v53, s[46:47]
  v_cndmask_b32 v54, v70, v54, s[64:65]
  v_cndmask_b32 v55, v71, v55, s[66:67]
  v_add_u32 v5, v5, v6
  ds_read_b64_tr_b16 v[24:25], v5 offset:0
  ds_read_b64_tr_b16 v[26:27], v5 offset:256
  ds_read_b64_tr_b16 v[28:29], v5 offset:512
  ds_read_b64_tr_b16 v[30:31], v5 offset:768
  v_exp_f32 v40, v40
  v_exp_f32 v41, v41
  v_exp_f32 v42, v42
  v_exp_f32 v43, v43
  v_exp_f32 v44, v44
  v_exp_f32 v45, v45
  v_exp_f32 v46, v46
  v_exp_f32 v47, v47
  v_exp_f32 v48, v48
  v_exp_f32 v49, v49
  v_exp_f32 v50, v50
  v_exp_f32 v51, v51
  v_exp_f32 v52, v52
  v_exp_f32 v53, v53
  v_exp_f32 v54, v54
  v_exp_f32 v55, v55
  v_cndmask_b32 v56, 0, v40, s[4:5]
  v_cndmask_b32 v57, 0, v41, s[6:7]
  v_cndmask_b32 v58, 0, v42, s[8:9]
  v_cndmask_b32 v59, 0, v43, s[10:11]
  v_cndmask_b32 v60, 0, v44, s[12:13]
  v_cndmask_b32 v61, 0, v45, s[14:15]
  v_cndmask_b32 v62, 0, v46, s[16:17]
  v_cndmask_b32 v63, 0, v47, s[18:19]
  v_cndmask_b32 v64, 0, v48, s[20:21]
  s_barrier
  v_cndmask_b32 v65, 0, v49, s[22:23]
  v_cndmask_b32 v66, 0, v50, s[40:41]
  v_cndmask_b32 v67, 0, v51, s[42:43]
  v_cndmask_b32 v68, 0, v52, s[44:45]
  v_cndmask_b32 v69, 0, v53, s[46:47]
  v_cndmask_b32 v70, 0, v54, s[64:65]
  v_cndmask_b32 v71, 0, v55, s[66:67]
  v_cvt_pk_bf16_f32 v32, v56, v57
  v_cvt_pk_bf16_f32 v33, v58, v59
  v_cvt_pk_bf16_f32 v34, v60, v61
  v_cvt_pk_bf16_f32 v35, v62, v63
  v_cvt_pk_bf16_f32 v36, v64, v65
  v_cvt_pk_bf16_f32 v37, v66, v67
  v_cvt_pk_bf16_f32 v38, v68, v69
  v_cvt_pk_bf16_f32 v39, v70, v71
  s_waitcnt lgkmcnt(0)
  v_mfma_f32_32x32x16_bf16 v[96:111], v[24:27], v[32:35], v[96:111]
  v_cndmask_b32 v40, v40, 0, s[4:5]
  v_cndmask_b32 v41, v41, 0, s[6:7]
  v_cndmask_b32 v42, v42, 0, s[8:9]
  v_cndmask_b32 v43, v43, 0, s[10:11]
  v_cndmask_b32 v44, v44, 0, s[12:13]
  v_cndmask_b32 v45, v45, 0, s[14:15]
  v_cndmask_b32 v46, v46, 0, s[16:17]
  v_cndmask_b32 v47, v47, 0, s[18:19]
  v_mfma_f32_32x32x16_bf16 v[96:111], v[28:31], v[36:39], v[96:111]
  v_lshlrev_b32 v16, 3, v6
  v_sub_u32 v5, v5, v16
  ds_read_b64_tr_b16 v[24:25], v5 offset:0
  ds_read_b64_tr_b16 v[26:27], v5 offset:256
  ds_read_b64_tr_b16 v[28:29], v5 offset:512
  ds_read_b64_tr_b16 v[30:31], v5 offset:768
  v_cndmask_b32 v48, v48, 0, s[20:21]
  v_cndmask_b32 v49, v49, 0, s[22:23]
  v_cndmask_b32 v50, v50, 0, s[40:41]
  v_cndmask_b32 v51, v51, 0, s[42:43]
  v_cndmask_b32 v52, v52, 0, s[44:45]
  v_cndmask_b32 v53, v53, 0, s[46:47]
  v_cndmask_b32 v54, v54, 0, s[64:65]
  v_cndmask_b32 v55, v55, 0, s[66:67]
  v_cvt_pk_bf16_f32 v8, v40, v41
  v_cvt_pk_bf16_f32 v9, v42, v43
  v_cvt_pk_bf16_f32 v10, v44, v45
  v_cvt_pk_bf16_f32 v11, v46, v47
  v_cvt_pk_bf16_f32 v12, v48, v49
  v_cvt_pk_bf16_f32 v13, v50, v51
  v_cvt_pk_bf16_f32 v14, v52, v53
  v_cvt_pk_bf16_f32 v15, v54, v55
  s_waitcnt lgkmcnt(0)
  v_mfma_f32_32x32x16_bf16 v[96:111], v[24:27], v[8:11], v[96:111]
  v_mfma_f32_32x32x16_bf16 v[96:111], v[28:31], v[12:15], v[96:111]
  s_lshl_b32 s97, s81, 16
  s_lshl_b32 s98, s82, 13
  s_add_u32 s97, s97, s98
  s_add_u32 s97, s97, s90
  s_add_u32 s97, s97, 7341056
  s_mov_b32 s98, 1
  s_nop 5
  v_cmp_nlt_f32 vcc, v104, v7
  s_nop 4
  s_cbranch_vccnz L_fb
L_fbd1:
  v_rcp_f32 v1, v104
  s_nop 0
  v_mul_f32 v96, v96, v1
  v_mul_f32 v97, v97, v1
  v_mul_f32 v98, v98, v1
  v_mul_f32 v99, v99, v1
  v_mul_f32 v100, v100, v1
  v_mul_f32 v101, v101, v1
  v_mul_f32 v102, v102, v1
  v_mul_f32 v103, v103, v1
  v_cvt_pk_bf16_f32 v56, v96, v97
  v_cvt_pk_bf16_f32 v57, v98, v99
  v_cvt_pk_bf16_f32 v58, v100, v101
  v_cvt_pk_bf16_f32 v59, v102, v103
  buffer_store_dwordx4 v[56:59], v72, s[48:51], s97 offen sc1
  s_lshl_b32 s69, s84, 16
  s_lshl_b32 s70, s58, 15
  s_add_u32 s69, s69, s70
  s_lshl_b32 s70, s85, 7
  s_add_u32 s69, s69, s70
  s_lshr_b32 s70, s86, 1
  s_lshl_b32 s70, s70, 6
  s_add_u32 s69, s69, s70
  v_and_b32 v8, 31, v0
  v_lshrrev_b32 v9, 5, v0
  v_lshlrev_b32 v4, 10, v8
  v_lshl_add_u32 v4, v9, 4, v4
  v_add_u32 v4, s69, v4
  v_lshlrev_b32 v7, 6, v8
  v_lshl_add_u32 v7, v9, 3, v7
  v_lshrrev_b32 v6, 2, v0
  v_lshlrev_b32 v6, 10, v6
  v_and_b32 v8, 3, v0
  v_lshl_add_u32 v6, v8, 4, v6
  s_add_u32 s70, s69, 0x4000
  s_add_u32 s71, s90, 126976
  v_add_u32 v7, s71, v7
  s_lshl_b32 s97, s82, 2
  s_add_u32 s97, s97, s86
  s_lshl_b32 s97, s97, 7
  s_lshl_b32 s98, s81, 2
  s_add_u32 s97, s97, s98
  s_add_u32 s97, s97, 15740928
  v_mov_b32 v5, s96
  s_barrier
  s_mov_b32 m0, s71
  s_lshl_b32 s76, s84, 7
  buffer_load_dwordx4 v6, s[24:27], s69 offen lds
  s_add_u32 m0, s71, 1024
  s_add_u32 s76, s76, 15740928
  buffer_load_dwordx4 v6, s[24:27], s70 offen lds
  v_and_b32 v74, 31, v0
  v_lshlrev_b32 v74, 2, v74
  s_waitcnt vmcnt(2)
  s_mov_b64 exec, 1
  buffer_store_dword v5, off, s[48:51], s97 sc1
  s_mov_b64 exec, -1
  s_lshl_b32 s97, s84, 11
  s_lshl_b32 s69, s58, 10
  s_add_u32 s97, s97, s69
  s_add_u32 s97, s97, 7340032
  v_mov_b32 v73, 0
  s_barrier
  s_barrier
  s_barrier
  s_barrier
  buffer_load_dword v73, v74, s[48:51], s76 offen sc1
  s_barrier
  buffer_load_dword v73, v74, s[48:51], s76 offen sc1
  s_mov_b32 s80, 0
  s_waitcnt vmcnt(1)
L_p3:
  v_cmp_ne_u32 vcc, s96, v73
  s_add_u32 s80, s80, 1
  s_cmp_gt_u32 s80, 0x20000
  s_cbranch_scc1 L_p3d
  s_nop 2
  s_cbranch_vccz L_p3d
  s_sleep 4
  buffer_load_dword v73, v74, s[48:51], s76 offen sc1
  s_waitcnt vmcnt(2)
  s_branch L_p3
L_p3d:
  buffer_load_dwordx4 v[16:19], v72, s[48:51], s97 offen
  s_add_u32 s97, s97, 0x10000
  buffer_load_dwordx4 v[20:23], v72, s[48:51], s97 offen
  s_add_u32 s97, s97, 0x10000
  buffer_load_dwordx4 v[24:27], v72, s[48:51], s97 offen
  s_add_u32 s97, s97, 0x10000
  buffer_load_dwordx4 v[28:31], v72, s[48:51], s97 offen
  s_add_u32 s97, s97, 0x10000
  buffer_load_dwordx4 v[32:35], v72, s[48:51], s97 offen
  s_add_u32 s97, s97, 0x10000
  buffer_load_dwordx4 v[36:39], v72, s[48:51], s97 offen
  s_add_u32 s97, s97, 0x10000
  buffer_load_dwordx4 v[40:43], v72, s[48:51], s97 offen
  s_add_u32 s97, s97, 0x10000
  buffer_load_dwordx4 v[44:47], v72, s[48:51], s97 offen
  s_add_u32 s97, s97, 0x10000
  buffer_load_dwordx4 v[48:51], v72, s[48:51], s97 offen
  s_add_u32 s97, s97, 0x10000
  buffer_load_dwordx4 v[52:55], v72, s[48:51], s97 offen
  s_add_u32 s97, s97, 0x10000
  buffer_load_dwordx4 v[56:59], v72, s[48:51], s97 offen
  s_add_u32 s97, s97, 0x10000
  buffer_load_dwordx4 v[60:63], v72, s[48:51], s97 offen
  s_add_u32 s97, s97, 0x10000
  buffer_load_dwordx4 v[64:67], v72, s[48:51], s97 offen
  s_add_u32 s97, s97, 0x10000
  buffer_load_dwordx4 v[68:71], v72, s[48:51], s97 offen
  s_add_u32 s97, s97, 0x10000
  buffer_load_dwordx4 v[76:79], v72, s[48:51], s97 offen
  s_add_u32 s97, s97, 0x10000
  buffer_load_dwordx4 v[80:83], v72, s[48:51], s97 offen
  s_add_u32 s97, s97, 0x10000
  buffer_load_dwordx4 v[84:87], v72, s[48:51], s97 offen
  s_add_u32 s97, s97, 0x10000
  buffer_load_dwordx4 v[88:91], v72, s[48:51], s97 offen
  s_add_u32 s97, s97, 0x10000
  buffer_load_dwordx4 v[92:95], v72, s[48:51], s97 offen
  s_add_u32 s97, s97, 0x10000
  buffer_load_dwordx4 v[96:99], v72, s[48:51], s97 offen
  s_add_u32 s97, s97, 0x10000
  buffer_load_dwordx4 v[100:103], v72, s[48:51], s97 offen
  s_add_u32 s97, s97, 0x10000
  buffer_load_dwordx4 v[104:107], v72, s[48:51], s97 offen
  s_add_u32 s97, s97, 0x10000
  buffer_load_dwordx4 v[108:111], v72, s[48:51], s97 offen
  s_waitcnt vmcnt(22)
  v_mfma_f32_32x32x16_bf16 v[112:127], v[128:131], v[16:19], 0
  s_add_u32 s97, s97, 0x10000
  buffer_load_dwordx4 v[128:131], v72, s[48:51], s97 offen
  s_waitcnt vmcnt(22)
  v_mfma_f32_32x32x16_bf16 v[112:127], v[132:135], v[20:23], v[112:127]
  s_add_u32 s97, s97, 0x10000
  buffer_load_dwordx4 v[132:135], v72, s[48:51], s97 offen
  s_waitcnt vmcnt(22)
  v_mfma_f32_32x32x16_bf16 v[112:127], v[136:139], v[24:27], v[112:127]
  s_add_u32 s97, s97, 0x10000
  buffer_load_dwordx4 v[136:139], v72, s[48:51], s97 offen
  s_waitcnt vmcnt(22)
  v_mfma_f32_32x32x16_bf16 v[112:127], v[140:143], v[28:31], v[112:127]
  s_add_u32 s97, s97, 0x10000
  buffer_load_dwordx4 v[140:143], v72, s[48:51], s97 offen
  s_waitcnt vmcnt(22)
  v_mfma_f32_32x32x16_bf16 v[112:127], v[144:147], v[32:35], v[112:127]
  s_add_u32 s97, s97, 0x10000
  buffer_load_dwordx4 v[144:147], v72, s[48:51], s97 offen
  s_waitcnt vmcnt(22)
  v_mfma_f32_32x32x16_bf16 v[112:127], v[148:151], v[36:39], v[112:127]
  s_add_u32 s97, s97, 0x10000
  buffer_load_dwordx4 v[148:151], v72, s[48:51], s97 offen
  s_waitcnt vmcnt(22)
  v_mfma_f32_32x32x16_bf16 v[112:127], v[152:155], v[40:43], v[112:127]
  s_add_u32 s97, s97, 0x10000
  buffer_load_dwordx4 v[152:155], v72, s[48:51], s97 offen
  s_waitcnt vmcnt(22)
  v_mfma_f32_32x32x16_bf16 v[112:127], v[156:159], v[44:47], v[112:127]
  s_add_u32 s97, s97, 0x10000
  buffer_load_dwordx4 v[156:159], v72, s[48:51], s97 offen
  s_waitcnt vmcnt(22)
  v_mfma_f32_32x32x16_bf16 v[112:127], v[160:163], v[48:51], v[112:127]
  s_add_u32 s97, s97, 0x10000
  buffer_load_dwordx4 v[160:163], v72, s[48:51], s97 offen
  s_waitcnt vmcnt(22)
  v_mfma_f32_32x32x16_bf16 v[112:127], v[164:167], v[52:55], v[112:127]
  ds_read_b64 v[8:9], v7 offset:0
  ds_read_b64 v[10:11], v7 offset:16
  ds_read_b64 v[12:13], v7 offset:32
  ds_read_b64 v[14:15], v7 offset:48
  s_waitcnt vmcnt(21)
  v_mfma_f32_32x32x16_bf16 v[112:127], v[168:171], v[56:59], v[112:127]
  s_waitcnt vmcnt(20)
  v_mfma_f32_32x32x16_bf16 v[112:127], v[172:175], v[60:63], v[112:127]
  s_waitcnt vmcnt(19)
  v_mfma_f32_32x32x16_bf16 v[112:127], v[176:179], v[64:67], v[112:127]
  s_waitcnt vmcnt(18)
  v_mfma_f32_32x32x16_bf16 v[112:127], v[180:183], v[68:71], v[112:127]
  s_waitcnt lgkmcnt(0)
  s_waitcnt vmcnt(17)
  v_mfma_f32_32x32x16_bf16 v[112:127], v[184:187], v[76:79], v[112:127]
  v_lshlrev_b32 v16, 16, v8
  v_and_b32 v17, 0xffff0000, v8
  s_waitcnt vmcnt(16)
  v_mfma_f32_32x32x16_bf16 v[112:127], v[188:191], v[80:83], v[112:127]
  v_lshlrev_b32 v18, 16, v9
  v_and_b32 v19, 0xffff0000, v9
  s_waitcnt vmcnt(15)
  v_mfma_f32_32x32x16_bf16 v[112:127], v[192:195], v[84:87], v[112:127]
  v_lshlrev_b32 v20, 16, v10
  v_and_b32 v21, 0xffff0000, v10
  s_waitcnt vmcnt(14)
  v_mfma_f32_32x32x16_bf16 v[112:127], v[196:199], v[88:91], v[112:127]
  v_lshlrev_b32 v22, 16, v11
  v_and_b32 v23, 0xffff0000, v11
  s_waitcnt vmcnt(13)
  v_mfma_f32_32x32x16_bf16 v[112:127], v[200:203], v[92:95], v[112:127]
  v_lshlrev_b32 v24, 16, v12
  v_and_b32 v25, 0xffff0000, v12
  s_waitcnt vmcnt(12)
  v_mfma_f32_32x32x16_bf16 v[112:127], v[204:207], v[96:99], v[112:127]
  v_lshlrev_b32 v26, 16, v13
  v_and_b32 v27, 0xffff0000, v13
  s_waitcnt vmcnt(11)
  v_mfma_f32_32x32x16_bf16 v[112:127], v[208:211], v[100:103], v[112:127]
  v_lshlrev_b32 v28, 16, v14
  v_and_b32 v29, 0xffff0000, v14
  s_waitcnt vmcnt(10)
  v_mfma_f32_32x32x16_bf16 v[112:127], v[212:215], v[104:107], v[112:127]
  v_lshlrev_b32 v30, 16, v15
  v_and_b32 v31, 0xffff0000, v15
  s_waitcnt vmcnt(9)
  v_mfma_f32_32x32x16_bf16 v[112:127], v[216:219], v[108:111], v[112:127]
  s_waitcnt vmcnt(8)
  v_mfma_f32_32x32x16_bf16 v[112:127], v[220:223], v[128:131], v[112:127]
  s_waitcnt vmcnt(7)
  v_mfma_f32_32x32x16_bf16 v[112:127], v[224:227], v[132:135], v[112:127]
  s_waitcnt vmcnt(6)
  v_mfma_f32_32x32x16_bf16 v[112:127], v[228:231], v[136:139], v[112:127]
  s_waitcnt vmcnt(5)
  v_mfma_f32_32x32x16_bf16 v[112:127], v[232:235], v[140:143], v[112:127]
  s_waitcnt vmcnt(4)
  v_mfma_f32_32x32x16_bf16 v[112:127], v[236:239], v[144:147], v[112:127]
  s_barrier
  s_lshl_b32 s69, s86, 12
  v_add_u32 v5, s69, v72
  ds_read_b128 v[168:171], v5 offset:0
  ds_read_b128 v[172:175], v5 offset:1024
  ds_read_b128 v[176:179], v5 offset:2048
  ds_read_b128 v[180:183], v5 offset:3072
  s_waitcnt vmcnt(3)
  v_mfma_f32_32x32x16_bf16 v[112:127], v[240:243], v[148:151], v[112:127]
  s_waitcnt vmcnt(2)
  v_mfma_f32_32x32x16_bf16 v[112:127], v[244:247], v[152:155], v[112:127]
  s_waitcnt vmcnt(1)
  v_mfma_f32_32x32x16_bf16 v[112:127], v[248:251], v[156:159], v[112:127]
  s_waitcnt vmcnt(0)
  v_mfma_f32_32x32x16_bf16 v[112:127], v[252:255], v[160:163], v[112:127]
  s_waitcnt lgkmcnt(0)
  s_nop 10
  v_fmac_f32 v16, v112, v168
  v_fmac_f32 v17, v113, v169
  v_fmac_f32 v18, v114, v170
  v_fmac_f32 v19, v115, v171
  v_fmac_f32 v20, v116, v172
  v_fmac_f32 v21, v117, v173
  v_fmac_f32 v22, v118, v174
  v_fmac_f32 v23, v119, v175
  v_fmac_f32 v24, v120, v176
  v_fmac_f32 v25, v121, v177
  v_fmac_f32 v26, v122, v178
  v_fmac_f32 v27, v123, v179
  v_fmac_f32 v28, v124, v180
  v_fmac_f32 v29, v125, v181
  v_fmac_f32 v30, v126, v182
  v_fmac_f32 v31, v127, v183
  v_cvt_pk_bf16_f32 v32, v16, v17
  v_cvt_pk_bf16_f32 v33, v18, v19
  v_cvt_pk_bf16_f32 v34, v20, v21
  v_cvt_pk_bf16_f32 v35, v22, v23
  v_cvt_pk_bf16_f32 v36, v24, v25
  v_cvt_pk_bf16_f32 v37, v26, v27
  v_cvt_pk_bf16_f32 v38, v28, v29
  v_cvt_pk_bf16_f32 v39, v30, v31
  v_permlane32_swap_b32 v32, v34
  v_permlane32_swap_b32 v33, v35
  buffer_store_dwordx4 v[32:35], v4, s[36:39], 0 offen offset:0
  v_permlane32_swap_b32 v36, v38
  v_permlane32_swap_b32 v37, v39
  buffer_store_dwordx4 v[36:39], v4, s[36:39], 0 offen offset:32
  s_branch L_fin
L_B:
  ds_read_b128 v[80:83], v167 offset:0
  ds_read_b128 v[84:87], v167 offset:32
  ds_read_b128 v[88:91], v167 offset:64
  ds_read_b128 v[92:95], v167 offset:96
  ds_read_b128 v[96:99], v167 offset:128
  ds_read_b128 v[100:103], v167 offset:160
  ds_read_b128 v[104:107], v167 offset:192
  ds_read_b128 v[108:111], v167 offset:224
  s_waitcnt lgkmcnt(4)
  v_fmac_f32 v40, v14, v80
  v_fmac_f32 v41, v14, v81
  v_fmac_f32 v42, v14, v82
  v_fmac_f32 v43, v14, v83
  v_fmac_f32 v44, v14, v84
  v_fmac_f32 v45, v14, v85
  v_fmac_f32 v46, v14, v86
  v_fmac_f32 v47, v14, v87
  v_fmac_f32 v48, v14, v88
  v_fmac_f32 v49, v14, v89
  v_fmac_f32 v50, v14, v90
  v_fmac_f32 v51, v14, v91
  v_fmac_f32 v52, v14, v92
  v_fmac_f32 v53, v14, v93
  v_fmac_f32 v54, v14, v94
  v_fmac_f32 v55, v14, v95
  s_waitcnt lgkmcnt(0)
  v_fmac_f32 v56, v14, v96
  v_fmac_f32 v57, v14, v97
  v_fmac_f32 v58, v14, v98
  v_fmac_f32 v59, v14, v99
  v_fmac_f32 v60, v14, v100
  v_fmac_f32 v61, v14, v101
  v_fmac_f32 v62, v14, v102
  v_fmac_f32 v63, v14, v103
  v_fmac_f32 v64, v14, v104
  v_fmac_f32 v65, v14, v105
  v_fmac_f32 v66, v14, v106
  v_fmac_f32 v67, v14, v107
  v_fmac_f32 v68, v14, v108
  v_fmac_f32 v69, v14, v109
  v_fmac_f32 v70, v14, v110
  v_fmac_f32 v71, v14, v111
  s_lshl_b32 s97, s75, 1
  s_add_u32 s97, s97, s58
  s_lshl_b32 s97, s97, 7
  s_lshl_b32 s98, s59, 2
  s_add_u32 s97, s97, s98
  s_add_u32 s97, s97, s57
  s_lshl_b32 s97, s97, 10
  s_add_u32 s98, s97, 0x10000
  v_mul_f32 v88, v40, v40
  v_mul_f32 v89, v41, v41
  v_mul_f32 v90, v42, v42
  v_mul_f32 v91, v43, v43
  v_fma_f32 v88, v88, v18, v17
  v_fma_f32 v89, v89, v18, v17
  v_fma_f32 v90, v90, v18, v17
  v_fma_f32 v91, v91, v18, v17
  v_mul_f32 v88, v88, v40
  s_add_u32 s70, s63, 2
  s_sub_u32 s71, s70, 6
  s_min_u32 s70, s70, s71
  s_add_u32 m0, s90, 98304
  s_lshl_b32 s68, s70, 16
  v_mul_f32 v89, v89, v41
  v_mul_f32 v90, v90, v42
  v_mul_f32 v91, v91, v43
  v_exp_f32 v88, v88
  v_exp_f32 v89, v89
  v_exp_f32 v90, v90
  v_exp_f32 v91, v91
  v_mul_f32 v40, v40, v56
  v_mul_f32 v41, v41, v57
  v_mul_f32 v42, v42, v58
  v_mul_f32 v43, v43, v59
  v_fma_f32 v88, v88, v16, v16
  v_fma_f32 v89, v89, v16, v16
  v_fma_f32 v90, v90, v16, v16
  v_fma_f32 v91, v91, v16, v16
  v_rcp_f32 v88, v88
  v_rcp_f32 v89, v89
  buffer_load_dwordx4 v3, s[28:31], s68 offen lds
  v_rcp_f32 v90, v90
  v_rcp_f32 v91, v91
  v_mul_f32 v40, v40, v88
  v_mul_f32 v41, v41, v89
  v_mul_f32 v42, v42, v90
  v_mul_f32 v43, v43, v91
  v_cvt_pk_bf16_f32 v80, v40, v41
  v_cvt_pk_bf16_f32 v81, v42, v43
  v_mul_f32 v88, v44, v44
  v_mul_f32 v89, v45, v45
  v_mul_f32 v90, v46, v46
  v_mul_f32 v91, v47, v47
  v_fma_f32 v88, v88, v18, v17
  v_fma_f32 v89, v89, v18, v17
  v_fma_f32 v90, v90, v18, v17
  v_fma_f32 v91, v91, v18, v17
  v_mul_f32 v88, v88, v44
  v_mul_f32 v89, v89, v45
  v_mul_f32 v90, v90, v46
  v_mul_f32 v91, v91, v47
  v_exp_f32 v88, v88
  v_exp_f32 v89, v89
  v_exp_f32 v90, v90
  v_exp_f32 v91, v91
  v_mul_f32 v44, v44, v60
  v_mul_f32 v45, v45, v61
  v_mul_f32 v46, v46, v62
  v_mul_f32 v47, v47, v63
  v_fma_f32 v88, v88, v16, v16
  v_fma_f32 v89, v89, v16, v16
  v_fma_f32 v90, v90, v16, v16
  v_fma_f32 v91, v91, v16, v16
  v_rcp_f32 v88, v88
  v_rcp_f32 v89, v89
  buffer_load_dwordx4 v2, s[28:31], s68 offen offset:1024 lds
  v_rcp_f32 v90, v90
  v_rcp_f32 v91, v91
  v_mul_f32 v44, v44, v88
  v_mul_f32 v45, v45, v89
  v_mul_f32 v46, v46, v90
  v_mul_f32 v47, v47, v91
  v_cvt_pk_bf16_f32 v82, v44, v45
  v_cvt_pk_bf16_f32 v83, v46, v47
  v_mul_f32 v88, v48, v48
  v_mul_f32 v89, v49, v49
  v_mul_f32 v90, v50, v50
  v_mul_f32 v91, v51, v51
  v_fma_f32 v88, v88, v18, v17
  v_fma_f32 v89, v89, v18, v17
  v_fma_f32 v90, v90, v18, v17
  v_fma_f32 v91, v91, v18, v17
  v_mul_f32 v88, v88, v48
  s_add_u32 m0, s90, 106496
  s_add_u32 s68, s68, 393216
  v_mul_f32 v89, v89, v49
  v_mul_f32 v90, v90, v50
  v_mul_f32 v91, v91, v51
  v_exp_f32 v88, v88
  v_exp_f32 v89, v89
  v_exp_f32 v90, v90
  v_exp_f32 v91, v91
  v_mul_f32 v48, v48, v64
  v_mul_f32 v49, v49, v65
  v_mul_f32 v50, v50, v66
  v_mul_f32 v51, v51, v67
  v_fma_f32 v88, v88, v16, v16
  v_fma_f32 v89, v89, v16, v16
  v_fma_f32 v90, v90, v16, v16
  v_fma_f32 v91, v91, v16, v16
  v_rcp_f32 v88, v88
  v_rcp_f32 v89, v89
  buffer_load_dwordx4 v3, s[28:31], s68 offen lds
  v_rcp_f32 v90, v90
  v_rcp_f32 v91, v91
  v_mul_f32 v48, v48, v88
  v_mul_f32 v49, v49, v89
  v_mul_f32 v50, v50, v90
  v_mul_f32 v51, v51, v91
  v_cvt_pk_bf16_f32 v84, v48, v49
  v_cvt_pk_bf16_f32 v85, v50, v51
  v_mul_f32 v88, v52, v52
  v_mul_f32 v89, v53, v53
  v_mul_f32 v90, v54, v54
  v_mul_f32 v91, v55, v55
  v_fma_f32 v88, v88, v18, v17
  v_fma_f32 v89, v89, v18, v17
  v_fma_f32 v90, v90, v18, v17
  v_fma_f32 v91, v91, v18, v17
  v_mul_f32 v88, v88, v52
  v_mul_f32 v89, v89, v53
  v_mul_f32 v90, v90, v54
  v_mul_f32 v91, v91, v55
  v_exp_f32 v88, v88
  v_exp_f32 v89, v89
  v_exp_f32 v90, v90
  v_exp_f32 v91, v91
  v_mul_f32 v52, v52, v68
  v_mul_f32 v53, v53, v69
  v_mul_f32 v54, v54, v70
  v_mul_f32 v55, v55, v71
  v_fma_f32 v88, v88, v16, v16
  v_fma_f32 v89, v89, v16, v16
  v_fma_f32 v90, v90, v16, v16
  v_fma_f32 v91, v91, v16, v16
  v_rcp_f32 v88, v88
  v_rcp_f32 v89, v89
  buffer_load_dwordx4 v2, s[28:31], s68 offen offset:1024 lds
  v_rcp_f32 v90, v90
  v_rcp_f32 v91, v91
  v_mul_f32 v52, v52, v88
  v_mul_f32 v53, v53, v89
  v_mul_f32 v54, v54, v90
  v_mul_f32 v55, v55, v91
  v_cvt_pk_bf16_f32 v86, v52, v53
  v_cvt_pk_bf16_f32 v87, v54, v55
  buffer_store_dwordx4 v[80:83], v72, s[48:51], s97 offen sc1
  buffer_store_dwordx4 v[84:87], v72, s[48:51], s98 offen sc1
  v_add_u32 v179, 0x4000, v179
  s_waitcnt vmcnt(6)
  s_barrier
  s_add_u32 s70, s63, 0
  s_sub_u32 s71, s70, 6
  s_min_u32 s70, s70, s71
  s_add_u32 m0, s90, 16384
  s_lshl_b32 s68, s70, 16
  buffer_load_dwordx4 v3, s[28:31], s68 offen lds
  buffer_load_dwordx4 v2, s[28:31], s68 offen offset:1024 lds
  s_add_u32 m0, s90, 24576
  s_add_u32 s68, s68, 393216
  buffer_load_dwordx4 v3, s[28:31], s68 offen lds
  buffer_load_dwordx4 v2, s[28:31], s68 offen offset:1024 lds
  s_add_u32 m0, s90, 0
  s_lshl_b32 s68, s70, 18
  s_add_u32 s68, s68, s88
  buffer_load_dwordx4 v72, s[48:51], s68 offen lds
  buffer_load_dwordx4 v72, s[48:51], s68 offen offset:1024 lds
  s_add_u32 m0, s90, 8192
  s_add_u32 s68, s68, 1572864
  buffer_load_dwordx4 v72, s[48:51], s68 offen lds
  buffer_load_dwordx4 v72, s[48:51], s68 offen offset:1024 lds
  s_add_u32 s70, s63, 1
  s_sub_u32 s71, s70, 6
  s_min_u32 s70, s70, s71
  s_add_u32 m0, s90, 57344
  s_lshl_b32 s68, s70, 16
  buffer_load_dwordx4 v3, s[28:31], s68 offen lds
  buffer_load_dwordx4 v2, s[28:31], s68 offen offset:1024 lds
  s_add_u32 m0, s90, 65536
  s_add_u32 s68, s68, 393216
  buffer_load_dwordx4 v3, s[28:31], s68 offen lds
  buffer_load_dwordx4 v2, s[28:31], s68 offen offset:1024 lds
  s_add_u32 m0, s90, 40960
  s_lshl_b32 s68, s70, 18
  s_add_u32 s68, s68, s88
  buffer_load_dwordx4 v72, s[48:51], s68 offen lds
  buffer_load_dwordx4 v72, s[48:51], s68 offen offset:1024 lds
  s_add_u32 m0, s90, 49152
  s_add_u32 s68, s68, 1572864
  buffer_load_dwordx4 v72, s[48:51], s68 offen lds
  buffer_load_dwordx4 v72, s[48:51], s68 offen offset:1024 lds
  s_waitcnt vmcnt(16)
  s_waitcnt vmcnt(8)
  s_barrier
  v_add_u32 v182, 0, v180
  v_add_u32 v184, 0, v179
  ds_read_b128 v[192:195], v182 offset:0
  ds_read_b64_tr_b16 v[196:197], v184 offset:0
  ds_read_b64_tr_b16 v[198:199], v184 offset:1024
  ds_read_b128 v[200:203], v182 offset:2048
  ds_read_b64_tr_b16 v[204:205], v184 offset:2048
  ds_read_b64_tr_b16 v[206:207], v184 offset:3072
  ds_read_b128 v[208:211], v182 offset:4096
  ds_read_b64_tr_b16 v[212:213], v184 offset:4096
  ds_read_b64_tr_b16 v[214:215], v184 offset:5120
  s_waitcnt lgkmcnt(6)
  v_mfma_f32_32x32x16_bf16 v[112:127], v[196:199], v[192:195], 0
  s_add_u32 s70, s63, 2
  s_sub_u32 s71, s70, 6
  s_min_u32 s70, s70, s71
  s_add_u32 m0, s90, 81920
  s_lshl_b32 s68, s70, 18
  s_add_u32 s68, s68, s88
  ds_read_b128 v[216:219], v182 offset:6144
  ds_read_b64_tr_b16 v[220:221], v184 offset:6144
  ds_read_b64_tr_b16 v[222:223], v184 offset:7168
  buffer_load_dwordx4 v72, s[48:51], s68 offen lds
  buffer_load_dwordx4 v72, s[48:51], s68 offen offset:1024 lds
  s_waitcnt lgkmcnt(6)
  v_mfma_f32_32x32x16_bf16 v[112:127], v[204:207], v[200:203], v[112:127]
  s_add_u32 m0, s90, 90112
  s_add_u32 s68, s68, 1572864
  ds_read_b128 v[224:227], v182 offset:8192
  ds_read_b64_tr_b16 v[228:229], v184 offset:8192
  ds_read_b64_tr_b16 v[230:231], v184 offset:9216
  buffer_load_dwordx4 v72, s[48:51], s68 offen lds
  buffer_load_dwordx4 v72, s[48:51], s68 offen offset:1024 lds
  s_waitcnt lgkmcnt(6)
  v_mfma_f32_32x32x16_bf16 v[112:127], v[212:215], v[208:211], v[112:127]
  ds_read_b128 v[192:195], v182 offset:10240
  ds_read_b64_tr_b16 v[196:197], v184 offset:10240
  ds_read_b64_tr_b16 v[198:199], v184 offset:11264
  s_waitcnt lgkmcnt(6)
  v_mfma_f32_32x32x16_bf16 v[112:127], v[220:223], v[216:219], v[112:127]
  ds_read_b128 v[200:203], v182 offset:12288
  ds_read_b64_tr_b16 v[204:205], v184 offset:12288
  ds_read_b64_tr_b16 v[206:207], v184 offset:13312
  s_waitcnt lgkmcnt(6)
  v_mfma_f32_32x32x16_bf16 v[112:127], v[228:231], v[224:227], v[112:127]
  ds_read_b128 v[208:211], v182 offset:14336
  ds_read_b64_tr_b16 v[212:213], v184 offset:14336
  ds_read_b64_tr_b16 v[214:215], v184 offset:15360
  s_waitcnt lgkmcnt(0)
  s_waitcnt vmcnt(4)
  s_barrier
  v_add_u32 v183, 40960, v180
  v_add_u32 v185, 40960, v179
  v_mfma_f32_32x32x16_bf16 v[112:127], v[196:199], v[192:195], v[112:127]
  s_add_u32 s70, s63, 3
  s_sub_u32 s71, s70, 6
  s_min_u32 s70, s70, s71
  s_add_u32 m0, s90, 16384
  s_lshl_b32 s68, s70, 16
  ds_read_b128 v[216:219], v183 offset:0
  ds_read_b64_tr_b16 v[220:221], v185 offset:0
  ds_read_b64_tr_b16 v[222:223], v185 offset:1024
  buffer_load_dwordx4 v3, s[28:31], s68 offen lds
  buffer_load_dwordx4 v2, s[28:31], s68 offen offset:1024 lds
  v_mfma_f32_32x32x16_bf16 v[112:127], v[204:207], v[200:203], v[112:127]
  s_add_u32 m0, s90, 24576
  s_add_u32 s68, s68, 393216
  ds_read_b128 v[224:227], v183 offset:2048
  ds_read_b64_tr_b16 v[228:229], v185 offset:2048
  ds_read_b64_tr_b16 v[230:231], v185 offset:3072
  buffer_load_dwordx4 v3, s[28:31], s68 offen lds
  buffer_load_dwordx4 v2, s[28:31], s68 offen offset:1024 lds
  v_mfma_f32_32x32x16_bf16 v[112:127], v[212:215], v[208:211], v[112:127]
  s_add_u32 m0, s90, 0
  s_lshl_b32 s68, s70, 18
  s_add_u32 s68, s68, s88
  ds_read_b128 v[192:195], v183 offset:4096
  ds_read_b64_tr_b16 v[196:197], v185 offset:4096
  ds_read_b64_tr_b16 v[198:199], v185 offset:5120
  buffer_load_dwordx4 v72, s[48:51], s68 offen lds
  buffer_load_dwordx4 v72, s[48:51], s68 offen offset:1024 lds
  s_waitcnt lgkmcnt(6)
  v_mfma_f32_32x32x16_bf16 v[112:127], v[220:223], v[216:219], v[112:127]
  s_add_u32 m0, s90, 8192
  s_add_u32 s68, s68, 1572864
  ds_read_b128 v[200:203], v183 offset:6144
  ds_read_b64_tr_b16 v[204:205], v185 offset:6144
  ds_read_b64_tr_b16 v[206:207], v185 offset:7168
  buffer_load_dwordx4 v72, s[48:51], s68 offen lds
  buffer_load_dwordx4 v72, s[48:51], s68 offen offset:1024 lds
  s_waitcnt lgkmcnt(6)
  v_mfma_f32_32x32x16_bf16 v[112:127], v[228:231], v[224:227], v[112:127]
  ds_read_b128 v[208:211], v183 offset:8192
  ds_read_b64_tr_b16 v[212:213], v185 offset:8192
  ds_read_b64_tr_b16 v[214:215], v185 offset:9216
  s_waitcnt lgkmcnt(6)
  v_mfma_f32_32x32x16_bf16 v[112:127], v[196:199], v[192:195], v[112:127]
  ds_read_b128 v[216:219], v183 offset:10240
  ds_read_b64_tr_b16 v[220:221], v185 offset:10240
  ds_read_b64_tr_b16 v[222:223], v185 offset:11264
  s_waitcnt lgkmcnt(6)
  v_mfma_f32_32x32x16_bf16 v[112:127], v[204:207], v[200:203], v[112:127]
  ds_read_b128 v[224:227], v183 offset:12288
  ds_read_b64_tr_b16 v[228:229], v185 offset:12288
  ds_read_b64_tr_b16 v[230:231], v185 offset:13312
  s_waitcnt lgkmcnt(6)
  v_mfma_f32_32x32x16_bf16 v[112:127], v[212:215], v[208:211], v[112:127]
  ds_read_b128 v[192:195], v183 offset:14336
  ds_read_b64_tr_b16 v[196:197], v185 offset:14336
  ds_read_b64_tr_b16 v[198:199], v185 offset:15360
  s_waitcnt lgkmcnt(0)
  s_waitcnt vmcnt(8)
  s_barrier
  v_add_u32 v182, 81920, v180
  v_add_u32 v184, 81920, v179
  v_mfma_f32_32x32x16_bf16 v[112:127], v[220:223], v[216:219], v[112:127]
  s_add_u32 s70, s63, 4
  s_sub_u32 s71, s70, 6
  s_min_u32 s70, s70, s71
  s_add_u32 m0, s90, 57344
  s_lshl_b32 s68, s70, 16
  ds_read_b128 v[200:203], v182 offset:0
  ds_read_b64_tr_b16 v[204:205], v184 offset:0
  ds_read_b64_tr_b16 v[206:207], v184 offset:1024
  buffer_load_dwordx4 v3, s[28:31], s68 offen lds
  buffer_load_dwordx4 v2, s[28:31], s68 offen offset:1024 lds
  v_mfma_f32_32x32x16_bf16 v[112:127], v[228:231], v[224:227], v[112:127]
  s_add_u32 m0, s90, 65536
  s_add_u32 s68, s68, 393216
  ds_read_b128 v[208:211], v182 offset:2048
  ds_read_b64_tr_b16 v[212:213], v184 offset:2048
  ds_read_b64_tr_b16 v[214:215], v184 offset:3072
  buffer_load_dwordx4 v3, s[28:31], s68 offen lds
  buffer_load_dwordx4 v2, s[28:31], s68 offen offset:1024 lds
  v_mfma_f32_32x32x16_bf16 v[112:127], v[196:199], v[192:195], v[112:127]
  s_add_u32 m0, s90, 40960
  s_lshl_b32 s68, s70, 18
  s_add_u32 s68, s68, s88
  ds_read_b128 v[216:219], v182 offset:4096
  ds_read_b64_tr_b16 v[220:221], v184 offset:4096
  ds_read_b64_tr_b16 v[222:223], v184 offset:5120
  buffer_load_dwordx4 v72, s[48:51], s68 offen lds
  buffer_load_dwordx4 v72, s[48:51], s68 offen offset:1024 lds
  s_waitcnt lgkmcnt(6)
  v_mfma_f32_32x32x16_bf16 v[112:127], v[204:207], v[200:203], v[112:127]
  s_add_u32 m0, s90, 49152
  s_add_u32 s68, s68, 1572864
  ds_read_b128 v[224:227], v182 offset:6144
  ds_read_b64_tr_b16 v[228:229], v184 offset:6144
  ds_read_b64_tr_b16 v[230:231], v184 offset:7168
  buffer_load_dwordx4 v72, s[48:51], s68 offen lds
  buffer_load_dwordx4 v72, s[48:51], s68 offen offset:1024 lds
  s_waitcnt lgkmcnt(6)
  v_mfma_f32_32x32x16_bf16 v[112:127], v[212:215], v[208:211], v[112:127]
  ds_read_b128 v[192:195], v182 offset:8192
  ds_read_b64_tr_b16 v[196:197], v184 offset:8192
  ds_read_b64_tr_b16 v[198:199], v184 offset:9216
  s_waitcnt lgkmcnt(6)
  v_mfma_f32_32x32x16_bf16 v[112:127], v[220:223], v[216:219], v[112:127]
  ds_read_b128 v[200:203], v182 offset:10240
  ds_read_b64_tr_b16 v[204:205], v184 offset:10240
  ds_read_b64_tr_b16 v[206:207], v184 offset:11264
  s_waitcnt lgkmcnt(6)
  v_mfma_f32_32x32x16_bf16 v[112:127], v[228:231], v[224:227], v[112:127]
  ds_read_b128 v[208:211], v182 offset:12288
  ds_read_b64_tr_b16 v[212:213], v184 offset:12288
  ds_read_b64_tr_b16 v[214:215], v184 offset:13312
  s_waitcnt lgkmcnt(6)
  v_mfma_f32_32x32x16_bf16 v[112:127], v[196:199], v[192:195], v[112:127]
  ds_read_b128 v[216:219], v182 offset:14336
  ds_read_b64_tr_b16 v[220:221], v184 offset:14336
  ds_read_b64_tr_b16 v[222:223], v184 offset:15360
  s_waitcnt lgkmcnt(0)
  s_waitcnt vmcnt(8)
  s_barrier
  v_add_u32 v183, 0, v180
  v_add_u32 v185, 0, v179
  v_mfma_f32_32x32x16_bf16 v[112:127], v[204:207], v[200:203], v[112:127]
  s_add_u32 s70, s63, 5
  s_sub_u32 s71, s70, 6
  s_min_u32 s70, s70, s71
  s_add_u32 m0, s90, 98304
  s_lshl_b32 s68, s70, 16
  ds_read_b128 v[224:227], v183 offset:0
  ds_read_b64_tr_b16 v[228:229], v185 offset:0
  ds_read_b64_tr_b16 v[230:231], v185 offset:1024
  buffer_load_dwordx4 v3, s[28:31], s68 offen lds
  buffer_load_dwordx4 v2, s[28:31], s68 offen offset:1024 lds
  v_mfma_f32_32x32x16_bf16 v[112:127], v[212:215], v[208:211], v[112:127]
  s_add_u32 m0, s90, 106496
  s_add_u32 s68, s68, 393216
  ds_read_b128 v[192:195], v183 offset:2048
  ds_read_b64_tr_b16 v[196:197], v185 offset:2048
  ds_read_b64_tr_b16 v[198:199], v185 offset:3072
  buffer_load_dwordx4 v3, s[28:31], s68 offen lds
  buffer_load_dwordx4 v2, s[28:31], s68 offen offset:1024 lds
  v_mfma_f32_32x32x16_bf16 v[112:127], v[220:223], v[216:219], v[112:127]
  s_add_u32 m0, s90, 81920
  s_lshl_b32 s68, s70, 18
  s_add_u32 s68, s68, s88
  ds_read_b128 v[200:203], v183 offset:4096
  ds_read_b64_tr_b16 v[204:205], v185 offset:4096
  ds_read_b64_tr_b16 v[206:207], v185 offset:5120
  buffer_load_dwordx4 v72, s[48:51], s68 offen lds
  buffer_load_dwordx4 v72, s[48:51], s68 offen offset:1024 lds
  s_waitcnt lgkmcnt(6)
  v_mfma_f32_32x32x16_bf16 v[112:127], v[228:231], v[224:227], v[112:127]
  s_add_u32 m0, s90, 90112
  s_add_u32 s68, s68, 1572864
  ds_read_b128 v[208:211], v183 offset:6144
  ds_read_b64_tr_b16 v[212:213], v185 offset:6144
  ds_read_b64_tr_b16 v[214:215], v185 offset:7168
  buffer_load_dwordx4 v72, s[48:51], s68 offen lds
  buffer_load_dwordx4 v72, s[48:51], s68 offen offset:1024 lds
  s_waitcnt lgkmcnt(6)
  v_mfma_f32_32x32x16_bf16 v[112:127], v[196:199], v[192:195], v[112:127]
  ds_read_b128 v[216:219], v183 offset:8192
  ds_read_b64_tr_b16 v[220:221], v185 offset:8192
  ds_read_b64_tr_b16 v[222:223], v185 offset:9216
  s_waitcnt lgkmcnt(6)
  v_mfma_f32_32x32x16_bf16 v[112:127], v[204:207], v[200:203], v[112:127]
  ds_read_b128 v[224:227], v183 offset:10240
  ds_read_b64_tr_b16 v[228:229], v185 offset:10240
  ds_read_b64_tr_b16 v[230:231], v185 offset:11264
  s_waitcnt lgkmcnt(6)
  v_mfma_f32_32x32x16_bf16 v[112:127], v[212:215], v[208:211], v[112:127]
  ds_read_b128 v[192:195], v183 offset:12288
  ds_read_b64_tr_b16 v[196:197], v185 offset:12288
  ds_read_b64_tr_b16 v[198:199], v185 offset:13312
  s_waitcnt lgkmcnt(6)
  v_mfma_f32_32x32x16_bf16 v[112:127], v[220:223], v[216:219], v[112:127]
  ds_read_b128 v[200:203], v183 offset:14336
  ds_read_b64_tr_b16 v[204:205], v185 offset:14336
  ds_read_b64_tr_b16 v[206:207], v185 offset:15360
  s_waitcnt lgkmcnt(0)
  s_waitcnt vmcnt(8)
  s_barrier
  v_add_u32 v182, 40960, v180
  v_add_u32 v184, 40960, v179
  v_mfma_f32_32x32x16_bf16 v[112:127], v[228:231], v[224:227], v[112:127]
  s_add_u32 s70, s89, 0
  s_and_b32 s70, s70, 7
  s_add_u32 s70, s70, 12
  s_add_u32 m0, s90, 16384
  s_lshl_b32 s68, s70, 16
  ds_read_b128 v[208:211], v182 offset:0
  ds_read_b64_tr_b16 v[212:213], v184 offset:0
  ds_read_b64_tr_b16 v[214:215], v184 offset:1024
  buffer_load_dwordx4 v3, s[28:31], s68 offen lds
  buffer_load_dwordx4 v2, s[28:31], s68 offen offset:1024 lds
  v_mfma_f32_32x32x16_bf16 v[112:127], v[196:199], v[192:195], v[112:127]
  s_add_u32 m0, s90, 24576
  s_add_u32 s68, s68, 524288
  ds_read_b128 v[216:219], v182 offset:2048
  ds_read_b64_tr_b16 v[220:221], v184 offset:2048
  ds_read_b64_tr_b16 v[222:223], v184 offset:3072
  buffer_load_dwordx4 v3, s[28:31], s68 offen lds
  buffer_load_dwordx4 v2, s[28:31], s68 offen offset:1024 lds
  v_mfma_f32_32x32x16_bf16 v[112:127], v[204:207], v[200:203], v[112:127]
  s_add_u32 m0, s90, 0
  s_lshl_b32 s68, s70, 18
  s_add_u32 s68, s68, s88
  ds_read_b128 v[224:227], v182 offset:4096
  ds_read_b64_tr_b16 v[228:229], v184 offset:4096
  ds_read_b64_tr_b16 v[230:231], v184 offset:5120
  buffer_load_dwordx4 v72, s[48:51], s68 offen lds
  buffer_load_dwordx4 v72, s[48:51], s68 offen offset:1024 lds
  s_waitcnt lgkmcnt(6)
  v_mfma_f32_32x32x16_bf16 v[112:127], v[212:215], v[208:211], v[112:127]
  s_add_u32 m0, s90, 8192
  s_add_u32 s68, s68, 2097152
  ds_read_b128 v[192:195], v182 offset:6144
  ds_read_b64_tr_b16 v[196:197], v184 offset:6144
  ds_read_b64_tr_b16 v[198:199], v184 offset:7168
  buffer_load_dwordx4 v72, s[48:51], s68 offen lds
  buffer_load_dwordx4 v72, s[48:51], s68 offen offset:1024 lds
  s_waitcnt lgkmcnt(6)
  v_mfma_f32_32x32x16_bf16 v[112:127], v[220:223], v[216:219], v[112:127]
  ds_read_b128 v[200:203], v182 offset:8192
  ds_read_b64_tr_b16 v[204:205], v184 offset:8192
  ds_read_b64_tr_b16 v[206:207], v184 offset:9216
  s_waitcnt lgkmcnt(6)
  v_mfma_f32_32x32x16_bf16 v[112:127], v[228:231], v[224:227], v[112:127]
  ds_read_b128 v[208:211], v182 offset:10240
  ds_read_b64_tr_b16 v[212:213], v184 offset:10240
  ds_read_b64_tr_b16 v[214:215], v184 offset:11264
  s_waitcnt lgkmcnt(6)
  v_mfma_f32_32x32x16_bf16 v[112:127], v[196:199], v[192:195], v[112:127]
  ds_read_b128 v[216:219], v182 offset:12288
  ds_read_b64_tr_b16 v[220:221], v184 offset:12288
  ds_read_b64_tr_b16 v[222:223], v184 offset:13312
  s_waitcnt lgkmcnt(6)
  v_mfma_f32_32x32x16_bf16 v[112:127], v[204:207], v[200:203], v[112:127]
  ds_read_b128 v[224:227], v182 offset:14336
  ds_read_b64_tr_b16 v[228:229], v184 offset:14336
  ds_read_b64_tr_b16 v[230:231], v184 offset:15360
  s_waitcnt lgkmcnt(0)
  s_waitcnt vmcnt(8)
  s_barrier
  v_add_u32 v183, 81920, v180
  v_add_u32 v185, 81920, v179
  v_mfma_f32_32x32x16_bf16 v[112:127], v[212:215], v[208:211], v[112:127]
  s_add_u32 s70, s89, 1
  s_and_b32 s70, s70, 7
  s_add_u32 s70, s70, 12
  s_add_u32 m0, s90, 57344
  s_lshl_b32 s68, s70, 16
  ds_read_b128 v[192:195], v183 offset:0
  ds_read_b64_tr_b16 v[196:197], v185 offset:0
  ds_read_b64_tr_b16 v[198:199], v185 offset:1024
  buffer_load_dwordx4 v3, s[28:31], s68 offen lds
  buffer_load_dwordx4 v2, s[28:31], s68 offen offset:1024 lds
  v_mfma_f32_32x32x16_bf16 v[112:127], v[220:223], v[216:219], v[112:127]
  s_add_u32 m0, s90, 65536
  s_add_u32 s68, s68, 524288
  ds_read_b128 v[200:203], v183 offset:2048
  ds_read_b64_tr_b16 v[204:205], v185 offset:2048
  ds_read_b64_tr_b16 v[206:207], v185 offset:3072
  buffer_load_dwordx4 v3, s[28:31], s68 offen lds
  buffer_load_dwordx4 v2, s[28:31], s68 offen offset:1024 lds
  v_mfma_f32_32x32x16_bf16 v[112:127], v[228:231], v[224:227], v[112:127]
  s_add_u32 m0, s90, 40960
  s_lshl_b32 s68, s70, 18
  s_add_u32 s68, s68, s88
  ds_read_b128 v[208:211], v183 offset:4096
  ds_read_b64_tr_b16 v[212:213], v185 offset:4096
  ds_read_b64_tr_b16 v[214:215], v185 offset:5120
  buffer_load_dwordx4 v72, s[48:51], s68 offen lds
  buffer_load_dwordx4 v72, s[48:51], s68 offen offset:1024 lds
  s_waitcnt lgkmcnt(6)
  v_mfma_f32_32x32x16_bf16 v[112:127], v[196:199], v[192:195], v[112:127]
  s_add_u32 m0, s90, 49152
  s_add_u32 s68, s68, 2097152
  ds_read_b128 v[216:219], v183 offset:6144
  ds_read_b64_tr_b16 v[220:221], v185 offset:6144
  ds_read_b64_tr_b16 v[222:223], v185 offset:7168
  buffer_load_dwordx4 v72, s[48:51], s68 offen lds
  buffer_load_dwordx4 v72, s[48:51], s68 offen offset:1024 lds
  s_waitcnt lgkmcnt(6)
  v_mfma_f32_32x32x16_bf16 v[112:127], v[204:207], v[200:203], v[112:127]
  ds_read_b128 v[224:227], v183 offset:8192
  ds_read_b64_tr_b16 v[228:229], v185 offset:8192
  ds_read_b64_tr_b16 v[230:231], v185 offset:9216
  s_waitcnt lgkmcnt(6)
  v_mfma_f32_32x32x16_bf16 v[112:127], v[212:215], v[208:211], v[112:127]
  ds_read_b128 v[192:195], v183 offset:10240
  ds_read_b64_tr_b16 v[196:197], v185 offset:10240
  ds_read_b64_tr_b16 v[198:199], v185 offset:11264
  s_waitcnt lgkmcnt(6)
  v_mfma_f32_32x32x16_bf16 v[112:127], v[220:223], v[216:219], v[112:127]
  ds_read_b128 v[200:203], v183 offset:12288
  ds_read_b64_tr_b16 v[204:205], v185 offset:12288
  ds_read_b64_tr_b16 v[206:207], v185 offset:13312
  s_waitcnt lgkmcnt(6)
  v_mfma_f32_32x32x16_bf16 v[112:127], v[228:231], v[224:227], v[112:127]
  ds_read_b128 v[208:211], v183 offset:14336
  ds_read_b64_tr_b16 v[212:213], v185 offset:14336
  ds_read_b64_tr_b16 v[214:215], v185 offset:15360
  s_waitcnt lgkmcnt(0)
  s_waitcnt vmcnt(8)
  s_barrier
  v_add_u32 v182, 0, v180
  v_add_u32 v184, 0, v179
  v_mfma_f32_32x32x16_bf16 v[112:127], v[196:199], v[192:195], v[112:127]
  s_add_u32 s70, s89, 2
  s_and_b32 s70, s70, 7
  s_add_u32 s70, s70, 12
  s_add_u32 m0, s90, 98304
  s_lshl_b32 s68, s70, 16
  ds_read_b128 v[216:219], v182 offset:0
  ds_read_b64_tr_b16 v[220:221], v184 offset:0
  ds_read_b64_tr_b16 v[222:223], v184 offset:1024
  buffer_load_dwordx4 v3, s[28:31], s68 offen lds
  buffer_load_dwordx4 v2, s[28:31], s68 offen offset:1024 lds
  v_mfma_f32_32x32x16_bf16 v[112:127], v[204:207], v[200:203], v[112:127]
  s_add_u32 m0, s90, 106496
  s_add_u32 s68, s68, 524288
  ds_read_b128 v[224:227], v182 offset:2048
  ds_read_b64_tr_b16 v[228:229], v184 offset:2048
  ds_read_b64_tr_b16 v[230:231], v184 offset:3072
  buffer_load_dwordx4 v3, s[28:31], s68 offen lds
  buffer_load_dwordx4 v2, s[28:31], s68 offen offset:1024 lds
  v_mfma_f32_32x32x16_bf16 v[112:127], v[212:215], v[208:211], v[112:127]
  s_add_u32 m0, s90, 81920
  s_lshl_b32 s68, s70, 18
  s_add_u32 s68, s68, s88
  ds_read_b128 v[192:195], v182 offset:4096
  ds_read_b64_tr_b16 v[196:197], v184 offset:4096
  ds_read_b64_tr_b16 v[198:199], v184 offset:5120
  buffer_load_dwordx4 v72, s[48:51], s68 offen lds
  buffer_load_dwordx4 v72, s[48:51], s68 offen offset:1024 lds
  s_waitcnt lgkmcnt(6)
  v_mfma_f32_32x32x16_bf16 v[112:127], v[220:223], v[216:219], v[112:127]
  s_add_u32 m0, s90, 90112
  s_add_u32 s68, s68, 2097152
  ds_read_b128 v[200:203], v182 offset:6144
  ds_read_b64_tr_b16 v[204:205], v184 offset:6144
  ds_read_b64_tr_b16 v[206:207], v184 offset:7168
  buffer_load_dwordx4 v72, s[48:51], s68 offen lds
  buffer_load_dwordx4 v72, s[48:51], s68 offen offset:1024 lds
  s_waitcnt lgkmcnt(6)
  v_mfma_f32_32x32x16_bf16 v[112:127], v[228:231], v[224:227], v[112:127]
  ds_read_b128 v[208:211], v182 offset:8192
  ds_read_b64_tr_b16 v[212:213], v184 offset:8192
  ds_read_b64_tr_b16 v[214:215], v184 offset:9216
  s_waitcnt lgkmcnt(6)
  v_mfma_f32_32x32x16_bf16 v[112:127], v[196:199], v[192:195], v[112:127]
  ds_read_b128 v[216:219], v182 offset:10240
  ds_read_b64_tr_b16 v[220:221], v184 offset:10240
  ds_read_b64_tr_b16 v[222:223], v184 offset:11264
  s_waitcnt lgkmcnt(6)
  v_mfma_f32_32x32x16_bf16 v[112:127], v[204:207], v[200:203], v[112:127]
  ds_read_b128 v[224:227], v182 offset:12288
  ds_read_b64_tr_b16 v[228:229], v184 offset:12288
  ds_read_b64_tr_b16 v[230:231], v184 offset:13312
  s_waitcnt lgkmcnt(6)
  v_mfma_f32_32x32x16_bf16 v[112:127], v[212:215], v[208:211], v[112:127]
  ds_read_b128 v[192:195], v182 offset:14336
  ds_read_b64_tr_b16 v[196:197], v184 offset:14336
  ds_read_b64_tr_b16 v[198:199], v184 offset:15360
  s_waitcnt lgkmcnt(0)
  s_waitcnt vmcnt(8)
  s_barrier
  v_add_u32 v183, 40960, v180
  v_add_u32 v185, 40960, v179
  v_mfma_f32_32x32x16_bf16 v[112:127], v[220:223], v[216:219], v[112:127]
  s_add_u32 s70, s89, 3
  s_and_b32 s70, s70, 7
  s_add_u32 s70, s70, 12
  s_add_u32 m0, s90, 16384
  s_lshl_b32 s68, s70, 16
  ds_read_b128 v[200:203], v183 offset:0
  ds_read_b64_tr_b16 v[204:205], v185 offset:0
  ds_read_b64_tr_b16 v[206:207], v185 offset:1024
  buffer_load_dwordx4 v3, s[28:31], s68 offen lds
  buffer_load_dwordx4 v2, s[28:31], s68 offen offset:1024 lds
  v_mfma_f32_32x32x16_bf16 v[112:127], v[228:231], v[224:227], v[112:127]
  s_add_u32 m0, s90, 24576
  s_add_u32 s68, s68, 524288
  ds_read_b128 v[208:211], v183 offset:2048
  ds_read_b64_tr_b16 v[212:213], v185 offset:2048
  ds_read_b64_tr_b16 v[214:215], v185 offset:3072
  buffer_load_dwordx4 v3, s[28:31], s68 offen lds
  buffer_load_dwordx4 v2, s[28:31], s68 offen offset:1024 lds
  v_mfma_f32_32x32x16_bf16 v[112:127], v[196:199], v[192:195], v[112:127]
  s_add_u32 m0, s90, 0
  s_lshl_b32 s68, s70, 18
  s_add_u32 s68, s68, s88
  ds_read_b128 v[216:219], v183 offset:4096
  ds_read_b64_tr_b16 v[220:221], v185 offset:4096
  ds_read_b64_tr_b16 v[222:223], v185 offset:5120
  buffer_load_dwordx4 v72, s[48:51], s68 offen lds
  buffer_load_dwordx4 v72, s[48:51], s68 offen offset:1024 lds
  s_waitcnt lgkmcnt(6)
  v_mfma_f32_32x32x16_bf16 v[112:127], v[204:207], v[200:203], v[112:127]
  s_add_u32 m0, s90, 8192
  s_add_u32 s68, s68, 2097152
  ds_read_b128 v[224:227], v183 offset:6144
  ds_read_b64_tr_b16 v[228:229], v185 offset:6144
  ds_read_b64_tr_b16 v[230:231], v185 offset:7168
  buffer_load_dwordx4 v72, s[48:51], s68 offen lds
  buffer_load_dwordx4 v72, s[48:51], s68 offen offset:1024 lds
  s_waitcnt lgkmcnt(6)
  v_mfma_f32_32x32x16_bf16 v[112:127], v[212:215], v[208:211], v[112:127]
  ds_read_b128 v[192:195], v183 offset:8192
  ds_read_b64_tr_b16 v[196:197], v185 offset:8192
  ds_read_b64_tr_b16 v[198:199], v185 offset:9216
  s_waitcnt lgkmcnt(6)
  v_mfma_f32_32x32x16_bf16 v[112:127], v[220:223], v[216:219], v[112:127]
  ds_read_b128 v[200:203], v183 offset:10240
  ds_read_b64_tr_b16 v[204:205], v185 offset:10240
  ds_read_b64_tr_b16 v[206:207], v185 offset:11264
  s_waitcnt lgkmcnt(6)
  v_mfma_f32_32x32x16_bf16 v[112:127], v[228:231], v[224:227], v[112:127]
  ds_read_b128 v[208:211], v183 offset:12288
  ds_read_b64_tr_b16 v[212:213], v185 offset:12288
  ds_read_b64_tr_b16 v[214:215], v185 offset:13312
  s_waitcnt lgkmcnt(6)
  v_mfma_f32_32x32x16_bf16 v[112:127], v[196:199], v[192:195], v[112:127]
  ds_read_b128 v[216:219], v183 offset:14336
  ds_read_b64_tr_b16 v[220:221], v185 offset:14336
  ds_read_b64_tr_b16 v[222:223], v185 offset:15360
  s_waitcnt lgkmcnt(0)
  s_waitcnt vmcnt(8)
  s_barrier
  v_add_u32 v182, 81920, v180
  v_add_u32 v184, 81920, v179
  v_mfma_f32_32x32x16_bf16 v[112:127], v[204:207], v[200:203], v[112:127]
  s_add_u32 s70, s89, 4
  s_and_b32 s70, s70, 7
  s_add_u32 s70, s70, 12
  s_add_u32 m0, s90, 57344
  s_lshl_b32 s68, s70, 16
  ds_read_b128 v[224:227], v182 offset:0
  ds_read_b64_tr_b16 v[228:229], v184 offset:0
  ds_read_b64_tr_b16 v[230:231], v184 offset:1024
  buffer_load_dwordx4 v3, s[28:31], s68 offen lds
  buffer_load_dwordx4 v2, s[28:31], s68 offen offset:1024 lds
  v_mfma_f32_32x32x16_bf16 v[112:127], v[212:215], v[208:211], v[112:127]
  s_add_u32 m0, s90, 65536
  s_add_u32 s68, s68, 524288
  ds_read_b128 v[192:195], v182 offset:2048
  ds_read_b64_tr_b16 v[196:197], v184 offset:2048
  ds_read_b64_tr_b16 v[198:199], v184 offset:3072
  buffer_load_dwordx4 v3, s[28:31], s68 offen lds
  buffer_load_dwordx4 v2, s[28:31], s68 offen offset:1024 lds
  v_mfma_f32_32x32x16_bf16 v[112:127], v[220:223], v[216:219], v[112:127]
  s_add_u32 m0, s90, 40960
  s_lshl_b32 s68, s70, 18
  s_add_u32 s68, s68, s88
  ds_read_b128 v[200:203], v182 offset:4096
  ds_read_b64_tr_b16 v[204:205], v184 offset:4096
  ds_read_b64_tr_b16 v[206:207], v184 offset:5120
  buffer_load_dwordx4 v72, s[48:51], s68 offen lds
  buffer_load_dwordx4 v72, s[48:51], s68 offen offset:1024 lds
  s_waitcnt lgkmcnt(6)
  v_mfma_f32_32x32x16_bf16 v[112:127], v[228:231], v[224:227], v[112:127]
  s_add_u32 m0, s90, 49152
  s_add_u32 s68, s68, 2097152
  ds_read_b128 v[208:211], v182 offset:6144
  ds_read_b64_tr_b16 v[212:213], v184 offset:6144
  ds_read_b64_tr_b16 v[214:215], v184 offset:7168
  buffer_load_dwordx4 v72, s[48:51], s68 offen lds
  buffer_load_dwordx4 v72, s[48:51], s68 offen offset:1024 lds
  s_waitcnt lgkmcnt(6)
  v_mfma_f32_32x32x16_bf16 v[112:127], v[196:199], v[192:195], v[112:127]
  ds_read_b128 v[216:219], v182 offset:8192
  ds_read_b64_tr_b16 v[220:221], v184 offset:8192
  ds_read_b64_tr_b16 v[222:223], v184 offset:9216
  s_waitcnt lgkmcnt(6)
  v_mfma_f32_32x32x16_bf16 v[112:127], v[204:207], v[200:203], v[112:127]
  ds_read_b128 v[224:227], v182 offset:10240
  ds_read_b64_tr_b16 v[228:229], v184 offset:10240
  ds_read_b64_tr_b16 v[230:231], v184 offset:11264
  s_waitcnt lgkmcnt(6)
  v_mfma_f32_32x32x16_bf16 v[112:127], v[212:215], v[208:211], v[112:127]
  ds_read_b128 v[192:195], v182 offset:12288
  ds_read_b64_tr_b16 v[196:197], v184 offset:12288
  ds_read_b64_tr_b16 v[198:199], v184 offset:13312
  s_waitcnt lgkmcnt(6)
  v_mfma_f32_32x32x16_bf16 v[112:127], v[220:223], v[216:219], v[112:127]
  ds_read_b128 v[200:203], v182 offset:14336
  ds_read_b64_tr_b16 v[204:205], v184 offset:14336
  ds_read_b64_tr_b16 v[206:207], v184 offset:15360
  s_waitcnt lgkmcnt(0)
  s_waitcnt vmcnt(8)
  s_barrier
  v_add_u32 v183, 0, v180
  v_add_u32 v185, 0, v179
  v_mfma_f32_32x32x16_bf16 v[112:127], v[228:231], v[224:227], v[112:127]
  s_add_u32 s70, s89, 5
  s_and_b32 s70, s70, 7
  s_add_u32 s70, s70, 12
  s_add_u32 m0, s90, 98304
  s_lshl_b32 s68, s70, 16
  ds_read_b128 v[208:211], v183 offset:0
  ds_read_b64_tr_b16 v[212:213], v185 offset:0
  ds_read_b64_tr_b16 v[214:215], v185 offset:1024
  buffer_load_dwordx4 v3, s[28:31], s68 offen lds
  buffer_load_dwordx4 v2, s[28:31], s68 offen offset:1024 lds
  v_mfma_f32_32x32x16_bf16 v[112:127], v[196:199], v[192:195], v[112:127]
  s_add_u32 m0, s90, 106496
  s_add_u32 s68, s68, 524288
  ds_read_b128 v[216:219], v183 offset:2048
  ds_read_b64_tr_b16 v[220:221], v185 offset:2048
  ds_read_b64_tr_b16 v[222:223], v185 offset:3072
  buffer_load_dwordx4 v3, s[28:31], s68 offen lds
  buffer_load_dwordx4 v2, s[28:31], s68 offen offset:1024 lds
  v_mfma_f32_32x32x16_bf16 v[112:127], v[204:207], v[200:203], v[112:127]
  s_add_u32 m0, s90, 81920
  s_lshl_b32 s68, s70, 18
  s_add_u32 s68, s68, s88
  ds_read_b128 v[224:227], v183 offset:4096
  ds_read_b64_tr_b16 v[228:229], v185 offset:4096
  ds_read_b64_tr_b16 v[230:231], v185 offset:5120
  buffer_load_dwordx4 v72, s[48:51], s68 offen lds
  buffer_load_dwordx4 v72, s[48:51], s68 offen offset:1024 lds
  s_waitcnt lgkmcnt(6)
  v_mfma_f32_32x32x16_bf16 v[112:127], v[212:215], v[208:211], v[112:127]
  s_add_u32 m0, s90, 90112
  s_add_u32 s68, s68, 2097152
  ds_read_b128 v[192:195], v183 offset:6144
  ds_read_b64_tr_b16 v[196:197], v185 offset:6144
  ds_read_b64_tr_b16 v[198:199], v185 offset:7168
  buffer_load_dwordx4 v72, s[48:51], s68 offen lds
  buffer_load_dwordx4 v72, s[48:51], s68 offen offset:1024 lds
  s_waitcnt lgkmcnt(6)
  v_mfma_f32_32x32x16_bf16 v[112:127], v[220:223], v[216:219], v[112:127]
  ds_read_b128 v[200:203], v183 offset:8192
  ds_read_b64_tr_b16 v[204:205], v185 offset:8192
  ds_read_b64_tr_b16 v[206:207], v185 offset:9216
  s_waitcnt lgkmcnt(6)
  v_mfma_f32_32x32x16_bf16 v[112:127], v[228:231], v[224:227], v[112:127]
  ds_read_b128 v[208:211], v183 offset:10240
  ds_read_b64_tr_b16 v[212:213], v185 offset:10240
  ds_read_b64_tr_b16 v[214:215], v185 offset:11264
  s_waitcnt lgkmcnt(6)
  v_mfma_f32_32x32x16_bf16 v[112:127], v[196:199], v[192:195], v[112:127]
  ds_read_b128 v[216:219], v183 offset:12288
  ds_read_b64_tr_b16 v[220:221], v185 offset:12288
  ds_read_b64_tr_b16 v[222:223], v185 offset:13312
  s_waitcnt lgkmcnt(6)
  v_mfma_f32_32x32x16_bf16 v[112:127], v[204:207], v[200:203], v[112:127]
  ds_read_b128 v[224:227], v183 offset:14336
  ds_read_b64_tr_b16 v[228:229], v185 offset:14336
  ds_read_b64_tr_b16 v[230:231], v185 offset:15360
  s_waitcnt lgkmcnt(0)
  s_waitcnt vmcnt(8)
  s_barrier
  v_add_u32 v182, 40960, v180
  v_add_u32 v184, 40960, v179
  v_mfma_f32_32x32x16_bf16 v[112:127], v[212:215], v[208:211], v[112:127]
  s_add_u32 s70, s89, 6
  s_and_b32 s70, s70, 7
  s_add_u32 s70, s70, 12
  s_add_u32 m0, s90, 16384
  s_lshl_b32 s68, s70, 16
  ds_read_b128 v[192:195], v182 offset:0
  ds_read_b64_tr_b16 v[196:197], v184 offset:0
  ds_read_b64_tr_b16 v[198:199], v184 offset:1024
  buffer_load_dwordx4 v3, s[28:31], s68 offen lds
  buffer_load_dwordx4 v2, s[28:31], s68 offen offset:1024 lds
  v_mfma_f32_32x32x16_bf16 v[112:127], v[220:223], v[216:219], v[112:127]
  s_add_u32 m0, s90, 24576
  s_add_u32 s68, s68, 524288
  ds_read_b128 v[200:203], v182 offset:2048
  ds_read_b64_tr_b16 v[204:205], v184 offset:2048
  ds_read_b64_tr_b16 v[206:207], v184 offset:3072
  buffer_load_dwordx4 v3, s[28:31], s68 offen lds
  buffer_load_dwordx4 v2, s[28:31], s68 offen offset:1024 lds
  v_mfma_f32_32x32x16_bf16 v[112:127], v[228:231], v[224:227], v[112:127]
  s_add_u32 m0, s90, 0
  s_lshl_b32 s68, s70, 18
  s_add_u32 s68, s68, s88
  ds_read_b128 v[208:211], v182 offset:4096
  ds_read_b64_tr_b16 v[212:213], v184 offset:4096
  ds_read_b64_tr_b16 v[214:215], v184 offset:5120
  buffer_load_dwordx4 v72, s[48:51], s68 offen lds
  buffer_load_dwordx4 v72, s[48:51], s68 offen offset:1024 lds
  s_waitcnt lgkmcnt(6)
  v_mfma_f32_32x32x16_bf16 v[112:127], v[196:199], v[192:195], v[112:127]
  s_add_u32 m0, s90, 8192
  s_add_u32 s68, s68, 2097152
  ds_read_b128 v[216:219], v182 offset:6144
  ds_read_b64_tr_b16 v[220:221], v184 offset:6144
  ds_read_b64_tr_b16 v[222:223], v184 offset:7168
  buffer_load_dwordx4 v72, s[48:51], s68 offen lds
  buffer_load_dwordx4 v72, s[48:51], s68 offen offset:1024 lds
  s_waitcnt lgkmcnt(6)
  v_mfma_f32_32x32x16_bf16 v[112:127], v[204:207], v[200:203], v[112:127]
  ds_read_b128 v[224:227], v182 offset:8192
  ds_read_b64_tr_b16 v[228:229], v184 offset:8192
  ds_read_b64_tr_b16 v[230:231], v184 offset:9216
  s_waitcnt lgkmcnt(6)
  v_mfma_f32_32x32x16_bf16 v[112:127], v[212:215], v[208:211], v[112:127]
  ds_read_b128 v[192:195], v182 offset:10240
  ds_read_b64_tr_b16 v[196:197], v184 offset:10240
  ds_read_b64_tr_b16 v[198:199], v184 offset:11264
  s_waitcnt lgkmcnt(6)
  v_mfma_f32_32x32x16_bf16 v[112:127], v[220:223], v[216:219], v[112:127]
  ds_read_b128 v[200:203], v182 offset:12288
  ds_read_b64_tr_b16 v[204:205], v184 offset:12288
  ds_read_b64_tr_b16 v[206:207], v184 offset:13312
  s_waitcnt lgkmcnt(6)
  v_mfma_f32_32x32x16_bf16 v[112:127], v[228:231], v[224:227], v[112:127]
  ds_read_b128 v[208:211], v182 offset:14336
  ds_read_b64_tr_b16 v[212:213], v184 offset:14336
  ds_read_b64_tr_b16 v[214:215], v184 offset:15360
  s_waitcnt lgkmcnt(0)
  s_waitcnt vmcnt(8)
  s_barrier
  v_add_u32 v183, 81920, v180
  v_add_u32 v185, 81920, v179
  v_mfma_f32_32x32x16_bf16 v[112:127], v[196:199], v[192:195], v[112:127]
  s_add_u32 s70, s89, 7
  s_and_b32 s70, s70, 7
  s_add_u32 s70, s70, 12
  s_add_u32 m0, s90, 57344
  s_lshl_b32 s68, s70, 16
  ds_read_b128 v[216:219], v183 offset:0
  ds_read_b64_tr_b16 v[220:221], v185 offset:0
  ds_read_b64_tr_b16 v[222:223], v185 offset:1024
  buffer_load_dwordx4 v3, s[28:31], s68 offen lds
  buffer_load_dwordx4 v2, s[28:31], s68 offen offset:1024 lds
  v_mfma_f32_32x32x16_bf16 v[112:127], v[204:207], v[200:203], v[112:127]
  s_add_u32 m0, s90, 65536
  s_add_u32 s68, s68, 524288
  ds_read_b128 v[224:227], v183 offset:2048
  ds_read_b64_tr_b16 v[228:229], v185 offset:2048
  ds_read_b64_tr_b16 v[230:231], v185 offset:3072
  buffer_load_dwordx4 v3, s[28:31], s68 offen lds
  buffer_load_dwordx4 v2, s[28:31], s68 offen offset:1024 lds
  v_mfma_f32_32x32x16_bf16 v[112:127], v[212:215], v[208:211], v[112:127]
  s_add_u32 m0, s90, 40960
  s_lshl_b32 s68, s70, 18
  s_add_u32 s68, s68, s88
  ds_read_b128 v[192:195], v183 offset:4096
  ds_read_b64_tr_b16 v[196:197], v185 offset:4096
  ds_read_b64_tr_b16 v[198:199], v185 offset:5120
  buffer_load_dwordx4 v72, s[48:51], s68 offen lds
  buffer_load_dwordx4 v72, s[48:51], s68 offen offset:1024 lds
  s_waitcnt lgkmcnt(6)
  v_mfma_f32_32x32x16_bf16 v[112:127], v[220:223], v[216:219], v[112:127]
  s_add_u32 m0, s90, 49152
  s_add_u32 s68, s68, 2097152
  ds_read_b128 v[200:203], v183 offset:6144
  ds_read_b64_tr_b16 v[204:205], v185 offset:6144
  ds_read_b64_tr_b16 v[206:207], v185 offset:7168
  buffer_load_dwordx4 v72, s[48:51], s68 offen lds
  buffer_load_dwordx4 v72, s[48:51], s68 offen offset:1024 lds
  s_waitcnt lgkmcnt(6)
  v_mfma_f32_32x32x16_bf16 v[112:127], v[228:231], v[224:227], v[112:127]
  ds_read_b128 v[208:211], v183 offset:8192
  ds_read_b64_tr_b16 v[212:213], v185 offset:8192
  ds_read_b64_tr_b16 v[214:215], v185 offset:9216
  s_waitcnt lgkmcnt(6)
  v_mfma_f32_32x32x16_bf16 v[112:127], v[196:199], v[192:195], v[112:127]
  ds_read_b128 v[216:219], v183 offset:10240
  ds_read_b64_tr_b16 v[220:221], v185 offset:10240
  ds_read_b64_tr_b16 v[222:223], v185 offset:11264
  s_waitcnt lgkmcnt(6)
  v_mfma_f32_32x32x16_bf16 v[112:127], v[204:207], v[200:203], v[112:127]
  ds_read_b128 v[224:227], v183 offset:12288
  ds_read_b64_tr_b16 v[228:229], v185 offset:12288
  ds_read_b64_tr_b16 v[230:231], v185 offset:13312
  s_waitcnt lgkmcnt(6)
  v_mfma_f32_32x32x16_bf16 v[112:127], v[212:215], v[208:211], v[112:127]
  ds_read_b128 v[192:195], v183 offset:14336
  ds_read_b64_tr_b16 v[196:197], v185 offset:14336
  ds_read_b64_tr_b16 v[198:199], v185 offset:15360
  s_waitcnt lgkmcnt(0)
  s_waitcnt vmcnt(8)
  s_barrier
  v_add_u32 v182, 0, v180
  v_add_u32 v184, 0, v179
  v_mfma_f32_32x32x16_bf16 v[112:127], v[220:223], v[216:219], v[112:127]
  ds_read_b128 v[200:203], v182 offset:0
  ds_read_b64_tr_b16 v[204:205], v184 offset:0
  ds_read_b64_tr_b16 v[206:207], v184 offset:1024
  v_mfma_f32_32x32x16_bf16 v[112:127], v[228:231], v[224:227], v[112:127]
  ds_read_b128 v[208:211], v182 offset:2048
  ds_read_b64_tr_b16 v[212:213], v184 offset:2048
  ds_read_b64_tr_b16 v[214:215], v184 offset:3072
  v_mfma_f32_32x32x16_bf16 v[112:127], v[196:199], v[192:195], v[112:127]
  ds_read_b128 v[216:219], v182 offset:4096
  ds_read_b64_tr_b16 v[220:221], v184 offset:4096
  ds_read_b64_tr_b16 v[222:223], v184 offset:5120
  s_waitcnt lgkmcnt(6)
  v_mfma_f32_32x32x16_bf16 v[112:127], v[204:207], v[200:203], v[112:127]
  ds_read_b128 v[224:227], v182 offset:6144
  ds_read_b64_tr_b16 v[228:229], v184 offset:6144
  ds_read_b64_tr_b16 v[230:231], v184 offset:7168
  s_waitcnt lgkmcnt(6)
  v_mfma_f32_32x32x16_bf16 v[112:127], v[212:215], v[208:211], v[112:127]
  ds_read_b128 v[192:195], v182 offset:8192
  ds_read_b64_tr_b16 v[196:197], v184 offset:8192
  ds_read_b64_tr_b16 v[198:199], v184 offset:9216
  s_waitcnt lgkmcnt(6)
  v_mfma_f32_32x32x16_bf16 v[112:127], v[220:223], v[216:219], v[112:127]
  ds_read_b128 v[200:203], v182 offset:10240
  ds_read_b64_tr_b16 v[204:205], v184 offset:10240
  ds_read_b64_tr_b16 v[206:207], v184 offset:11264
  s_waitcnt lgkmcnt(6)
  v_mfma_f32_32x32x16_bf16 v[112:127], v[228:231], v[224:227], v[112:127]
  ds_read_b128 v[208:211], v182 offset:12288
  ds_read_b64_tr_b16 v[212:213], v184 offset:12288
  ds_read_b64_tr_b16 v[214:215], v184 offset:13312
  s_waitcnt lgkmcnt(6)
  v_mfma_f32_32x32x16_bf16 v[112:127], v[196:199], v[192:195], v[112:127]
  ds_read_b128 v[216:219], v182 offset:14336
  ds_read_b64_tr_b16 v[220:221], v184 offset:14336
  ds_read_b64_tr_b16 v[222:223], v184 offset:15360
  s_waitcnt lgkmcnt(0)
  s_waitcnt vmcnt(0)
  s_barrier
  v_add_u32 v183, 40960, v180
  v_add_u32 v185, 40960, v179
  v_mfma_f32_32x32x16_bf16 v[112:127], v[204:207], v[200:203], v[112:127]
  ds_read_b128 v[224:227], v183 offset:0
  ds_read_b64_tr_b16 v[228:229], v185 offset:0
  ds_read_b64_tr_b16 v[230:231], v185 offset:1024
  v_mfma_f32_32x32x16_bf16 v[112:127], v[212:215], v[208:211], v[112:127]
  ds_read_b128 v[192:195], v183 offset:2048
  ds_read_b64_tr_b16 v[196:197], v185 offset:2048
  ds_read_b64_tr_b16 v[198:199], v185 offset:3072
  v_mfma_f32_32x32x16_bf16 v[112:127], v[220:223], v[216:219], v[112:127]
  ds_read_b128 v[200:203], v183 offset:4096
  ds_read_b64_tr_b16 v[204:205], v185 offset:4096
  ds_read_b64_tr_b16 v[206:207], v185 offset:5120
  s_waitcnt lgkmcnt(6)
  v_mfma_f32_32x32x16_bf16 v[112:127], v[228:231], v[224:227], v[112:127]
  ds_read_b128 v[208:211], v183 offset:6144
  ds_read_b64_tr_b16 v[212:213], v185 offset:6144
  ds_read_b64_tr_b16 v[214:215], v185 offset:7168
  s_waitcnt lgkmcnt(6)
  v_mfma_f32_32x32x16_bf16 v[112:127], v[196:199], v[192:195], v[112:127]
  ds_read_b128 v[216:219], v183 offset:8192
  ds_read_b64_tr_b16 v[220:221], v185 offset:8192
  ds_read_b64_tr_b16 v[222:223], v185 offset:9216
  s_waitcnt lgkmcnt(6)
  v_mfma_f32_32x32x16_bf16 v[112:127], v[204:207], v[200:203], v[112:127]
  ds_read_b128 v[224:227], v183 offset:10240
  ds_read_b64_tr_b16 v[228:229], v185 offset:10240
  ds_read_b64_tr_b16 v[230:231], v185 offset:11264
  s_waitcnt lgkmcnt(6)
  v_mfma_f32_32x32x16_bf16 v[112:127], v[212:215], v[208:211], v[112:127]
  ds_read_b128 v[192:195], v183 offset:12288
  ds_read_b64_tr_b16 v[196:197], v185 offset:12288
  ds_read_b64_tr_b16 v[198:199], v185 offset:13312
  s_waitcnt lgkmcnt(6)
  v_mfma_f32_32x32x16_bf16 v[112:127], v[220:223], v[216:219], v[112:127]
  ds_read_b128 v[200:203], v183 offset:14336
  ds_read_b64_tr_b16 v[204:205], v185 offset:14336
  ds_read_b64_tr_b16 v[206:207], v185 offset:15360
  s_waitcnt lgkmcnt(6)
  v_mfma_f32_32x32x16_bf16 v[112:127], v[228:231], v[224:227], v[112:127]
  s_waitcnt lgkmcnt(3)
  v_mfma_f32_32x32x16_bf16 v[112:127], v[196:199], v[192:195], v[112:127]
  s_waitcnt lgkmcnt(0)
  v_mfma_f32_32x32x16_bf16 v[112:127], v[204:207], v[200:203], v[112:127]
  s_nop 11
  v_mul_f32 v192, 0xbfb8aa3b, v112
  v_mul_f32 v193, 0xbfb8aa3b, v113
  v_mul_f32 v194, 0xbfb8aa3b, v114
  v_mul_f32 v195, 0xbfb8aa3b, v115
  v_mul_f32 v196, 0xbfb8aa3b, v116
  v_mul_f32 v197, 0xbfb8aa3b, v117
  v_mul_f32 v198, 0xbfb8aa3b, v118
  v_mul_f32 v199, 0xbfb8aa3b, v119
  v_mul_f32 v200, 0xbfb8aa3b, v120
  v_mul_f32 v201, 0xbfb8aa3b, v121
  v_mul_f32 v202, 0xbfb8aa3b, v122
  v_mul_f32 v203, 0xbfb8aa3b, v123
  v_mul_f32 v204, 0xbfb8aa3b, v124
  v_mul_f32 v205, 0xbfb8aa3b, v125
  v_mul_f32 v206, 0xbfb8aa3b, v126
  v_mul_f32 v207, 0xbfb8aa3b, v127
  v_exp_f32 v192, v192
  v_exp_f32 v193, v193
  v_exp_f32 v194, v194
  v_exp_f32 v195, v195
  v_exp_f32 v196, v196
  v_exp_f32 v197, v197
  v_exp_f32 v198, v198
  v_exp_f32 v199, v199
  v_exp_f32 v200, v200
  v_exp_f32 v201, v201
  v_exp_f32 v202, v202
  v_exp_f32 v203, v203
  v_exp_f32 v204, v204
  v_exp_f32 v205, v205
  v_exp_f32 v206, v206
  v_exp_f32 v207, v207
  s_lshl_b32 s69, s86, 12
  v_add_u32 v182, s69, v72
  v_add_f32 v192, 1.0, v192
  v_add_f32 v193, 1.0, v193
  v_add_f32 v194, 1.0, v194
  v_add_f32 v195, 1.0, v195
  v_add_f32 v196, 1.0, v196
  v_add_f32 v197, 1.0, v197
  v_add_f32 v198, 1.0, v198
  v_add_f32 v199, 1.0, v199
  v_add_f32 v200, 1.0, v200
  v_add_f32 v201, 1.0, v201
  v_add_f32 v202, 1.0, v202
  v_add_f32 v203, 1.0, v203
  v_add_f32 v204, 1.0, v204
  v_add_f32 v205, 1.0, v205
  v_add_f32 v206, 1.0, v206
  v_add_f32 v207, 1.0, v207
  v_rcp_f32 v192, v192
  v_rcp_f32 v193, v193
  v_rcp_f32 v194, v194
  v_rcp_f32 v195, v195
  v_rcp_f32 v196, v196
  v_rcp_f32 v197, v197
  v_rcp_f32 v198, v198
  v_rcp_f32 v199, v199
  v_rcp_f32 v200, v200
  v_rcp_f32 v201, v201
  v_rcp_f32 v202, v202
  v_rcp_f32 v203, v203
  v_rcp_f32 v204, v204
  v_rcp_f32 v205, v205
  v_rcp_f32 v206, v206
  v_rcp_f32 v207, v207
  v_mul_f32 v192, v112, v192
  v_mul_f32 v193, v113, v193
  v_mul_f32 v194, v114, v194
  v_mul_f32 v195, v115, v195
  v_mul_f32 v196, v116, v196
  v_mul_f32 v197, v117, v197
  v_mul_f32 v198, v118, v198
  v_mul_f32 v199, v119, v199
  v_mul_f32 v200, v120, v200
  v_mul_f32 v201, v121, v201
  v_mul_f32 v202, v122, v202
  v_mul_f32 v203, v123, v203
  v_mul_f32 v204, v124, v204
  v_mul_f32 v205, v125, v205
  v_mul_f32 v206, v126, v206
  v_mul_f32 v207, v127, v207
  ds_write_b128 v182, v[192:195] offset:0
  ds_write_b128 v182, v[196:199] offset:1024
  ds_write_b128 v182, v[200:203] offset:2048
  ds_write_b128 v182, v[204:207] offset:3072
  s_waitcnt lgkmcnt(0)
  s_barrier
L_fin:
L_end:
  s_endpgm
R1:
  s_nop 7
  s_nop 7
  s_memrealtime s[92:93]
  s_waitcnt lgkmcnt(0)
  s_or_b32 s92, s92, 1
  v_mov_b32 v36, s92
  s_mov_b64 exec, 1
  buffer_store_dword v36, off, s[52:55], 0 sc1
  s_mov_b64 exec, -1
  s_nop 7
  s_branch B1
R2:
  s_nop 7
  s_nop 7
  s_mov_b32 s80, 0
L_nc:
  s_sleep 2
  buffer_load_dword v73, off, s[52:55], 0 sc1
  s_waitcnt vmcnt(0)
  v_readfirstlane_b32 s96, v73
  s_add_u32 s80, s80, 1
  s_cmp_gt_u32 s80, 0x8000
  s_cbranch_scc1 L_nd
  s_cmp_eq_u32 s96, 0
  s_cbranch_scc1 L_nc
L_nd:
  s_nop 7
  s_branch B2
R3:
  s_nop 7
  s_nop 7
  s_lshr_b32 s92, s79, 4
  s_lshl_b32 s92, s92, 7
  s_and_b32 s93, s79, 15
  s_lshl_b32 s93, s93, 2
  s_add_u32 s92, s92, s93
  s_add_u32 s92, s92, 15728640
  v_mov_b32 v74, s96
  s_mov_b64 exec, 1
  buffer_store_dword v74, off, s[48:51], s92 sc1
  s_mov_b64 exec, -1
  s_nop 7
  s_branch B3
R4:
  s_nop 7
  s_nop 7
  v_lshrrev_b32 v74, 4, v0
  v_lshlrev_b32 v74, 7, v74
  v_and_b32 v73, 15, v0
  v_lshl_add_u32 v74, v73, 2, v74
  buffer_load_dword v73, v74, s[48:51], s76 offen sc1
  s_nop 7
  s_branch B4
R6:
  s_nop 7
  s_nop 7
  s_waitcnt vmcnt(0)
  s_mov_b32 s80, 0
L_pl5:
  v_cmp_ne_u32 vcc, s96, v73
  s_nop 4
  s_cbranch_vccz L_pd5
  s_add_u32 s80, s80, 1
  s_cmp_gt_u32 s80, 0x20000
  s_cbranch_scc1 L_pd5
  buffer_load_dword v73, v74, s[48:51], s76 offen sc1
  s_sleep 4
  s_waitcnt vmcnt(2)
  s_branch L_pl5
L_pd5:
  s_nop 7
  s_branch B6
R7:
  s_nop 7
  s_nop 7
  s_lshr_b32 s92, s79, 4
  s_lshl_b32 s92, s92, 7
  s_and_b32 s93, s79, 15
  s_lshl_b32 s93, s93, 2
  s_add_u32 s92, s92, s93
  s_add_u32 s92, s92, 15732736
  v_mov_b32 v74, s96
  s_mov_b64 exec, 1
  buffer_store_dword v74, off, s[48:51], s92 sc1
  s_mov_b64 exec, -1
  s_nop 7
  s_branch B7
R8:
  s_nop 7
  s_nop 7
  s_lshr_b32 s92, s79, 4
  s_lshl_b32 s92, s92, 7
  s_and_b32 s93, s79, 15
  s_lshl_b32 s93, s93, 2
  s_add_u32 s92, s92, s93
  s_add_u32 s92, s92, 15728640
  v_mov_b32 v74, s96
  s_mov_b64 exec, 1
  buffer_store_dword v74, off, s[48:51], s92 sc1
  s_mov_b64 exec, -1
  s_nop 7
  s_branch B8
R9:
  s_nop 7
  s_nop 7
  v_lshrrev_b32 v74, 4, v0
  v_lshlrev_b32 v74, 7, v74
  v_and_b32 v73, 15, v0
  v_lshl_add_u32 v74, v73, 2, v74
  buffer_load_dword v73, v74, s[48:51], s76 offen sc1
  s_nop 7
  s_branch B9
R11:
  s_nop 7
  s_nop 7
  s_waitcnt vmcnt(0)
  s_mov_b32 s80, 0
L_pl10:
  v_cmp_ne_u32 vcc, s96, v73
  s_nop 4
  s_cbranch_vccz L_pd10
  s_add_u32 s80, s80, 1
  s_cmp_gt_u32 s80, 0x20000
  s_cbranch_scc1 L_pd10
  buffer_load_dword v73, v74, s[48:51], s76 offen sc1
  s_sleep 4
  s_waitcnt vmcnt(2)
  s_branch L_pl10
L_pd10:
  s_nop 7
  s_branch B11
R12:
  s_nop 7
  s_nop 7
  s_lshr_b32 s92, s79, 4
  s_lshl_b32 s92, s92, 7
  s_and_b32 s93, s79, 15
  s_lshl_b32 s93, s93, 2
  s_add_u32 s92, s92, s93
  s_add_u32 s92, s92, 15732736
  v_mov_b32 v74, s96
  s_mov_b64 exec, 1
  buffer_store_dword v74, off, s[48:51], s92 sc1
  s_mov_b64 exec, -1
  s_nop 7
  s_branch B12
R13:
  s_nop 7
  s_nop 7
  v_and_b32 v74, 15, v0
  v_lshlrev_b32 v74, 2, v74
  buffer_load_dword v73, v74, s[48:51], s76 offen sc1
  s_nop 7
  s_branch B13
R15:
  s_nop 7
  s_nop 7
  s_waitcnt vmcnt(2)
  s_mov_b32 s80, 0
L_pl14:
  v_cmp_ne_u32 vcc, s96, v73
  s_nop 4
  s_cbranch_vccz L_pd14
  s_add_u32 s80, s80, 1
  s_cmp_gt_u32 s80, 0x20000
  s_cbranch_scc1 L_pd14
  buffer_load_dword v73, v74, s[48:51], s76 offen sc1
  s_sleep 4
  s_waitcnt vmcnt(2)
  s_branch L_pl14
L_pd14:
  s_nop 7
  s_branch B15
R16:
  s_nop 7
  s_nop 7
  v_mov_b32 v80, 0xf149f2ca
  v_mov_b32 v81, 0xf149f2ca
  v_mov_b32 v82, 0xf149f2ca
  v_mov_b32 v83, 0xf149f2ca
  v_mov_b32 v84, 0xf149f2ca
  v_mov_b32 v85, 0xf149f2ca
  v_mov_b32 v86, 0xf149f2ca
  v_mov_b32 v87, 0xf149f2ca
  v_mov_b32 v88, 0xf149f2ca
  v_mov_b32 v89, 0xf149f2ca
  v_mov_b32 v90, 0xf149f2ca
  v_mov_b32 v91, 0xf149f2ca
  v_mov_b32 v92, 0xf149f2ca
  v_mov_b32 v93, 0xf149f2ca
  v_mov_b32 v94, 0xf149f2ca
  v_mov_b32 v95, 0xf149f2ca
  s_nop 7
  s_branch B16
R17:
  s_nop 7
  s_nop 7
  v_sub_f32 v80, 0, v1
  v_sub_f32 v81, 0, v1
  v_sub_f32 v82, 0, v1
  v_sub_f32 v83, 0, v1
  v_sub_f32 v84, 0, v1
  v_sub_f32 v85, 0, v1
  v_sub_f32 v86, 0, v1
  v_sub_f32 v87, 0, v1
  v_sub_f32 v88, 0, v1
  v_sub_f32 v89, 0, v1
  v_sub_f32 v90, 0, v1
  v_sub_f32 v91, 0, v1
  v_sub_f32 v92, 0, v1
  v_sub_f32 v93, 0, v1
  v_sub_f32 v94, 0, v1
  v_sub_f32 v95, 0, v1
  s_nop 7
  s_branch B17
R18:
  s_nop 7
  s_nop 7
  v_sub_f32 v80, 0, v1
  v_sub_f32 v81, 0, v1
  v_sub_f32 v82, 0, v1
  v_sub_f32 v83, 0, v1
  v_sub_f32 v84, 0, v1
  v_sub_f32 v85, 0, v1
  v_sub_f32 v86, 0, v1
  v_sub_f32 v87, 0, v1
  v_sub_f32 v88, 0, v1
  v_sub_f32 v89, 0, v1
  v_sub_f32 v90, 0, v1
  v_sub_f32 v91, 0, v1
  v_sub_f32 v92, 0, v1
  v_sub_f32 v93, 0, v1
  v_sub_f32 v94, 0, v1
  v_sub_f32 v95, 0, v1
  s_nop 7
  s_branch B18
R19:
  s_nop 7
  s_nop 7
  v_sub_f32 v80, 0, v1
  v_sub_f32 v81, 0, v1
  v_sub_f32 v82, 0, v1
  v_sub_f32 v83, 0, v1
  v_sub_f32 v84, 0, v1
  v_sub_f32 v85, 0, v1
  v_sub_f32 v86, 0, v1
  v_sub_f32 v87, 0, v1
  v_sub_f32 v88, 0, v1
  v_sub_f32 v89, 0, v1
  v_sub_f32 v90, 0, v1
  v_sub_f32 v91, 0, v1
  v_sub_f32 v92, 0, v1
  v_sub_f32 v93, 0, v1
  v_sub_f32 v94, 0, v1
  v_sub_f32 v95, 0, v1
  s_nop 7
  s_branch B19
R20:
  s_nop 7
  s_nop 7
  v_sub_f32 v80, 0, v1
  v_sub_f32 v81, 0, v1
  v_sub_f32 v82, 0, v1
  v_sub_f32 v83, 0, v1
  v_sub_f32 v84, 0, v1
  v_sub_f32 v85, 0, v1
  v_sub_f32 v86, 0, v1
  v_sub_f32 v87, 0, v1
  v_sub_f32 v88, 0, v1
  v_sub_f32 v89, 0, v1
  v_sub_f32 v90, 0, v1
  v_sub_f32 v91, 0, v1
  v_sub_f32 v92, 0, v1
  v_sub_f32 v93, 0, v1
  v_sub_f32 v94, 0, v1
  v_sub_f32 v95, 0, v1
  s_nop 7
  s_branch B20
R21:
  s_nop 7
  s_nop 7
  s_lshr_b32 s92, s79, 4
  s_lshl_b32 s92, s92, 7
  s_and_b32 s93, s79, 15
  s_lshl_b32 s93, s93, 2
  s_add_u32 s92, s92, s93
  s_add_u32 s92, s92, 15736832
  v_mov_b32 v74, s96
  s_mov_b64 exec, 1
  buffer_store_dword v74, off, s[48:51], s92 sc1
  s_mov_b64 exec, -1
  s_nop 7
  s_branch B21
R22:
  s_nop 7
  s_nop 7
  v_sub_f32 v80, 0, v1
  v_sub_f32 v81, 0, v1
  v_sub_f32 v82, 0, v1
  v_sub_f32 v83, 0, v1
  v_sub_f32 v84, 0, v1
  v_sub_f32 v85, 0, v1
  v_sub_f32 v86, 0, v1
  v_sub_f32 v87, 0, v1
  v_sub_f32 v88, 0, v1
  v_sub_f32 v89, 0, v1
  v_sub_f32 v90, 0, v1
  v_sub_f32 v91, 0, v1
  v_sub_f32 v92, 0, v1
  v_sub_f32 v93, 0, v1
  v_sub_f32 v94, 0, v1
  v_sub_f32 v95, 0, v1
  s_nop 7
  s_branch B22
R23:
  s_nop 7
  s_nop 7
  v_sub_f32 v80, 0, v1
  v_sub_f32 v81, 0, v1
  v_sub_f32 v82, 0, v1
  v_sub_f32 v83, 0, v1
  v_sub_f32 v84, 0, v1
  v_sub_f32 v85, 0, v1
  v_sub_f32 v86, 0, v1
  v_sub_f32 v87, 0, v1
  v_sub_f32 v88, 0, v1
  v_sub_f32 v89, 0, v1
  v_sub_f32 v90, 0, v1
  v_sub_f32 v91, 0, v1
  v_sub_f32 v92, 0, v1
  v_sub_f32 v93, 0, v1
  v_sub_f32 v94, 0, v1
  v_sub_f32 v95, 0, v1
  s_nop 7
  s_branch B23
R24:
  s_nop 7
  s_nop 7
  v_sub_f32 v80, 0, v1
  v_sub_f32 v81, 0, v1
  v_sub_f32 v82, 0, v1
  v_sub_f32 v83, 0, v1
  v_sub_f32 v84, 0, v1
  v_sub_f32 v85, 0, v1
  v_sub_f32 v86, 0, v1
  v_sub_f32 v87, 0, v1
  v_sub_f32 v88, 0, v1
  v_sub_f32 v89, 0, v1
  v_sub_f32 v90, 0, v1
  v_sub_f32 v91, 0, v1
  v_sub_f32 v92, 0, v1
  v_sub_f32 v93, 0, v1
  v_sub_f32 v94, 0, v1
  v_sub_f32 v95, 0, v1
  s_nop 7
  s_branch B24
R25:
  s_nop 7
  s_nop 7
  s_nop 15
  v_mov_b32 v56, 0xf149f2ca
  v_mov_b32 v57, 0xf149f2ca
  v_mov_b32 v58, 0xf149f2ca
  v_mov_b32 v59, 0xf149f2ca
  v_mov_b32 v60, 0xf149f2ca
  v_mov_b32 v61, 0xf149f2ca
  v_mov_b32 v62, 0xf149f2ca
  v_mov_b32 v63, 0xf149f2ca
  v_mov_b32 v64, 0xf149f2ca
  v_mov_b32 v65, 0xf149f2ca
  v_mov_b32 v66, 0xf149f2ca
  v_mov_b32 v67, 0xf149f2ca
  v_mov_b32 v68, 0xf149f2ca
  v_mov_b32 v69, 0xf149f2ca
  v_mov_b32 v70, 0xf149f2ca
  v_mov_b32 v71, 0xf149f2ca
  s_nop 7
  s_branch B25
R26:
  s_nop 7
  s_nop 7
  v_and_b32 v74, 15, v0
  v_lshlrev_b32 v74, 2, v74
  buffer_load_dword v73, v74, s[48:51], s76 offen sc1
  s_nop 7
  s_branch B26
R27:
  s_nop 7
  s_nop 7
  v_mov_b32 v80, 0xf149f2ca
  v_mov_b32 v81, 0xf149f2ca
  v_mov_b32 v82, 0xf149f2ca
  v_mov_b32 v83, 0xf149f2ca
  v_mov_b32 v84, 0xf149f2ca
  v_mov_b32 v85, 0xf149f2ca
  v_mov_b32 v86, 0xf149f2ca
  v_mov_b32 v87, 0xf149f2ca
  v_mov_b32 v88, 0xf149f2ca
  v_mov_b32 v89, 0xf149f2ca
  v_mov_b32 v90, 0xf149f2ca
  v_mov_b32 v91, 0xf149f2ca
  v_mov_b32 v92, 0xf149f2ca
  v_mov_b32 v93, 0xf149f2ca
  v_mov_b32 v94, 0xf149f2ca
  v_mov_b32 v95, 0xf149f2ca
  s_nop 7
  s_branch B27
R28:
  s_nop 7
  s_nop 7
  v_sub_f32 v80, 0, v1
  v_sub_f32 v81, 0, v1
  v_sub_f32 v82, 0, v1
  v_sub_f32 v83, 0, v1
  v_sub_f32 v84, 0, v1
  v_sub_f32 v85, 0, v1
  v_sub_f32 v86, 0, v1
  v_sub_f32 v87, 0, v1
  v_sub_f32 v88, 0, v1
  v_sub_f32 v89, 0, v1
  v_sub_f32 v90, 0, v1
  v_sub_f32 v91, 0, v1
  v_sub_f32 v92, 0, v1
  v_sub_f32 v93, 0, v1
  v_sub_f32 v94, 0, v1
  v_sub_f32 v95, 0, v1
  s_nop 7
  s_branch B28
R29:
  s_nop 7
  s_nop 7
  v_sub_f32 v80, 0, v1
  v_sub_f32 v81, 0, v1
  v_sub_f32 v82, 0, v1
  v_sub_f32 v83, 0, v1
  v_sub_f32 v84, 0, v1
  v_sub_f32 v85, 0, v1
  v_sub_f32 v86, 0, v1
  v_sub_f32 v87, 0, v1
  v_sub_f32 v88, 0, v1
  v_sub_f32 v89, 0, v1
  v_sub_f32 v90, 0, v1
  v_sub_f32 v91, 0, v1
  v_sub_f32 v92, 0, v1
  v_sub_f32 v93, 0, v1
  v_sub_f32 v94, 0, v1
  v_sub_f32 v95, 0, v1
  s_nop 7
  s_branch B29
R30:
  s_nop 7
  s_nop 7
  v_sub_f32 v80, 0, v1
  v_sub_f32 v81, 0, v1
  v_sub_f32 v82, 0, v1
  v_sub_f32 v83, 0, v1
  v_sub_f32 v84, 0, v1
  v_sub_f32 v85, 0, v1
  v_sub_f32 v86, 0, v1
  v_sub_f32 v87, 0, v1
  v_sub_f32 v88, 0, v1
  v_sub_f32 v89, 0, v1
  v_sub_f32 v90, 0, v1
  v_sub_f32 v91, 0, v1
  v_sub_f32 v92, 0, v1
  v_sub_f32 v93, 0, v1
  v_sub_f32 v94, 0, v1
  v_sub_f32 v95, 0, v1
  s_nop 7
  s_branch B30
R32:
  s_nop 7
  s_nop 7
  s_waitcnt vmcnt(0)
  s_mov_b32 s80, 0
L_pl31:
  v_cmp_ne_u32 vcc, s96, v73
  s_nop 4
  s_cbranch_vccz L_pd31
  s_add_u32 s80, s80, 1
  s_cmp_gt_u32 s80, 0x20000
  s_cbranch_scc1 L_pd31
  buffer_load_dword v73, v74, s[48:51], s76 offen sc1
  s_sleep 4
  s_waitcnt vmcnt(2)
  s_branch L_pl31
L_pd31:
  s_nop 7
  s_branch B32
R33:
  s_nop 7
  s_nop 7
  v_sub_f32 v80, 0, v1
  v_sub_f32 v81, 0, v1
  v_sub_f32 v82, 0, v1
  v_sub_f32 v83, 0, v1
  v_sub_f32 v84, 0, v1
  v_sub_f32 v85, 0, v1
  v_sub_f32 v86, 0, v1
  v_sub_f32 v87, 0, v1
  v_sub_f32 v88, 0, v1
  v_sub_f32 v89, 0, v1
  v_sub_f32 v90, 0, v1
  v_sub_f32 v91, 0, v1
  v_sub_f32 v92, 0, v1
  v_sub_f32 v93, 0, v1
  v_sub_f32 v94, 0, v1
  v_sub_f32 v95, 0, v1
  s_nop 7
  s_branch B33
R34:
  s_nop 7
  s_nop 7
  v_sub_f32 v80, 0, v1
  v_sub_f32 v81, 0, v1
  v_sub_f32 v82, 0, v1
  v_sub_f32 v83, 0, v1
  v_sub_f32 v84, 0, v1
  v_sub_f32 v85, 0, v1
  v_sub_f32 v86, 0, v1
  v_sub_f32 v87, 0, v1
  v_sub_f32 v88, 0, v1
  v_sub_f32 v89, 0, v1
  v_sub_f32 v90, 0, v1
  v_sub_f32 v91, 0, v1
  v_sub_f32 v92, 0, v1
  v_sub_f32 v93, 0, v1
  v_sub_f32 v94, 0, v1
  v_sub_f32 v95, 0, v1
  s_nop 7
  s_branch B34
R35:
  s_nop 7
  s_nop 7
  v_sub_f32 v80, 0, v1
  v_sub_f32 v81, 0, v1
  v_sub_f32 v82, 0, v1
  v_sub_f32 v83, 0, v1
  v_sub_f32 v84, 0, v1
  v_sub_f32 v85, 0, v1
  v_sub_f32 v86, 0, v1
  v_sub_f32 v87, 0, v1
  v_sub_f32 v88, 0, v1
  v_sub_f32 v89, 0, v1
  v_sub_f32 v90, 0, v1
  v_sub_f32 v91, 0, v1
  v_sub_f32 v92, 0, v1
  v_sub_f32 v93, 0, v1
  v_sub_f32 v94, 0, v1
  v_sub_f32 v95, 0, v1
  s_nop 7
  s_branch B35
R36:
  s_nop 7
  s_nop 7
  v_sub_f32 v80, 0, v1
  v_sub_f32 v81, 0, v1
  v_sub_f32 v82, 0, v1
  v_sub_f32 v83, 0, v1
  v_sub_f32 v84, 0, v1
  v_sub_f32 v85, 0, v1
  v_sub_f32 v86, 0, v1
  v_sub_f32 v87, 0, v1
  v_sub_f32 v88, 0, v1
  v_sub_f32 v89, 0, v1
  v_sub_f32 v90, 0, v1
  v_sub_f32 v91, 0, v1
  v_sub_f32 v92, 0, v1
  v_sub_f32 v93, 0, v1
  v_sub_f32 v94, 0, v1
  v_sub_f32 v95, 0, v1
  s_nop 7
  s_branch B36
R37:
  s_nop 7
  s_nop 7
  s_nop 15
  v_mov_b32 v56, 0xf149f2ca
  v_mov_b32 v57, 0xf149f2ca
  v_mov_b32 v58, 0xf149f2ca
  v_mov_b32 v59, 0xf149f2ca
  v_mov_b32 v60, 0xf149f2ca
  v_mov_b32 v61, 0xf149f2ca
  v_mov_b32 v62, 0xf149f2ca
  v_mov_b32 v63, 0xf149f2ca
  v_mov_b32 v64, 0xf149f2ca
  v_mov_b32 v65, 0xf149f2ca
  v_mov_b32 v66, 0xf149f2ca
  v_mov_b32 v67, 0xf149f2ca
  v_mov_b32 v68, 0xf149f2ca
  v_mov_b32 v69, 0xf149f2ca
  v_mov_b32 v70, 0xf149f2ca
  v_mov_b32 v71, 0xf149f2ca
  s_nop 7
  s_branch B37
L_code_end:
L_fb:
  s_nop 15
  v_mov_b32 v1, 0xf149f2ca
  v_mov_b32 v56, 0xf149f2ca
  v_mov_b32 v57, 0xf149f2ca
  v_mov_b32 v58, 0xf149f2ca
  v_mov_b32 v59, 0xf149f2ca
  v_mov_b32 v60, 0xf149f2ca
  v_mov_b32 v61, 0xf149f2ca
  v_mov_b32 v62, 0xf149f2ca
  v_mov_b32 v63, 0xf149f2ca
  v_mov_b32 v64, 0xf149f2ca
  v_mov_b32 v65, 0xf149f2ca
  v_mov_b32 v66, 0xf149f2ca
  v_mov_b32 v67, 0xf149f2ca
  v_mov_b32 v68, 0xf149f2ca
  v_mov_b32 v69, 0xf149f2ca
  v_mov_b32 v70, 0xf149f2ca
  v_mov_b32 v71, 0xf149f2ca
  s_cmp_gt_i32 s83, 0
  s_cbranch_scc1 L_fm38
  ds_read_b128 v[16:19], v4 offset:0
  s_waitcnt lgkmcnt(0)
  v_mfma_f32_32x32x16_bf16 v[56:71], v[16:19], v[76:79], 0
L_fm38:
  ds_read_b128 v[16:19], v4 offset:8192
  s_waitcnt lgkmcnt(0)
  v_mfma_f32_32x32x16_bf16 v[40:55], v[16:19], v[76:79], 0
  s_nop 11
  v_cndmask_b32 v40, v56, v40, s[4:5]
  v_cndmask_b32 v41, v57, v41, s[6:7]
  v_cndmask_b32 v42, v58, v42, s[8:9]
  v_cndmask_b32 v43, v59, v43, s[10:11]
  v_cndmask_b32 v44, v60, v44, s[12:13]
  v_cndmask_b32 v45, v61, v45, s[14:15]
  v_cndmask_b32 v46, v62, v46, s[16:17]
  v_cndmask_b32 v47, v63, v47, s[18:19]
  v_cndmask_b32 v48, v64, v48, s[20:21]
  v_cndmask_b32 v49, v65, v49, s[22:23]
  v_cndmask_b32 v50, v66, v50, s[40:41]
  v_cndmask_b32 v51, v67, v51, s[42:43]
  v_cndmask_b32 v52, v68, v52, s[44:45]
  v_cndmask_b32 v53, v69, v53, s[46:47]
  v_cndmask_b32 v54, v70, v54, s[64:65]
  v_cndmask_b32 v55, v71, v55, s[66:67]
  v_max3_f32 v1, v40, v41, v1
  v_max3_f32 v1, v42, v43, v1
  v_max3_f32 v1, v44, v45, v1
  v_max3_f32 v1, v46, v47, v1
  v_max3_f32 v1, v48, v49, v1
  v_max3_f32 v1, v50, v51, v1
  v_max3_f32 v1, v52, v53, v1
  v_max3_f32 v1, v54, v55, v1
  s_cmp_gt_i32 s83, 1
  s_cbranch_scc1 L_fa39
  ds_read_b128 v[16:19], v4 offset:1024
  s_waitcnt lgkmcnt(0)
  v_mfma_f32_32x32x16_bf16 v[40:55], v[16:19], v[76:79], 0
  s_nop 11
  v_max3_f32 v1, v40, v41, v1
  v_max3_f32 v1, v42, v43, v1
  v_max3_f32 v1, v44, v45, v1
  v_max3_f32 v1, v46, v47, v1
  v_max3_f32 v1, v48, v49, v1
  v_max3_f32 v1, v50, v51, v1
  v_max3_f32 v1, v52, v53, v1
  v_max3_f32 v1, v54, v55, v1
L_fa39:
  s_cmp_gt_i32 s83, 2
  s_cbranch_scc1 L_fa40
  ds_read_b128 v[16:19], v4 offset:2048
  s_waitcnt lgkmcnt(0)
  v_mfma_f32_32x32x16_bf16 v[40:55], v[16:19], v[76:79], 0
  s_nop 11
  v_max3_f32 v1, v40, v41, v1
  v_max3_f32 v1, v42, v43, v1
  v_max3_f32 v1, v44, v45, v1
  v_max3_f32 v1, v46, v47, v1
  v_max3_f32 v1, v48, v49, v1
  v_max3_f32 v1, v50, v51, v1
  v_max3_f32 v1, v52, v53, v1
  v_max3_f32 v1, v54, v55, v1
L_fa40:
  s_cmp_gt_i32 s83, 3
  s_cbranch_scc1 L_fa41
  ds_read_b128 v[16:19], v4 offset:3072
  s_waitcnt lgkmcnt(0)
  v_mfma_f32_32x32x16_bf16 v[40:55], v[16:19], v[76:79], 0
  s_nop 11
  v_max3_f32 v1, v40, v41, v1
  v_max3_f32 v1, v42, v43, v1
  v_max3_f32 v1, v44, v45, v1
  v_max3_f32 v1, v46, v47, v1
  v_max3_f32 v1, v48, v49, v1
  v_max3_f32 v1, v50, v51, v1
  v_max3_f32 v1, v52, v53, v1
  v_max3_f32 v1, v54, v55, v1
L_fa41:
  s_cmp_gt_i32 s83, 4
  s_cbranch_scc1 L_fa42
  ds_read_b128 v[16:19], v4 offset:4096
  s_waitcnt lgkmcnt(0)
  v_mfma_f32_32x32x16_bf16 v[40:55], v[16:19], v[76:79], 0
  s_nop 11
  v_max3_f32 v1, v40, v41, v1
  v_max3_f32 v1, v42, v43, v1
  v_max3_f32 v1, v44, v45, v1
  v_max3_f32 v1, v46, v47, v1
  v_max3_f32 v1, v48, v49, v1
  v_max3_f32 v1, v50, v51, v1
  v_max3_f32 v1, v52, v53, v1
  v_max3_f32 v1, v54, v55, v1
L_fa42:
  s_cmp_gt_i32 s83, 5
  s_cbranch_scc1 L_fa43
  ds_read_b128 v[16:19], v4 offset:5120
  s_waitcnt lgkmcnt(0)
  v_mfma_f32_32x32x16_bf16 v[40:55], v[16:19], v[76:79], 0
  s_nop 11
  v_max3_f32 v1, v40, v41, v1
  v_max3_f32 v1, v42, v43, v1
  v_max3_f32 v1, v44, v45, v1
  v_max3_f32 v1, v46, v47, v1
  v_max3_f32 v1, v48, v49, v1
  v_max3_f32 v1, v50, v51, v1
  v_max3_f32 v1, v52, v53, v1
  v_max3_f32 v1, v54, v55, v1
L_fa43:
  s_cmp_gt_i32 s83, 6
  s_cbranch_scc1 L_fa44
  ds_read_b128 v[16:19], v4 offset:6144
  s_waitcnt lgkmcnt(0)
  v_mfma_f32_32x32x16_bf16 v[40:55], v[16:19], v[76:79], 0
  s_nop 11
  v_max3_f32 v1, v40, v41, v1
  v_max3_f32 v1, v42, v43, v1
  v_max3_f32 v1, v44, v45, v1
  v_max3_f32 v1, v46, v47, v1
  v_max3_f32 v1, v48, v49, v1
  v_max3_f32 v1, v50, v51, v1
  v_max3_f32 v1, v52, v53, v1
  v_max3_f32 v1, v54, v55, v1
L_fa44:
  s_cmp_gt_i32 s83, 7
  s_cbranch_scc1 L_fa45
  ds_read_b128 v[16:19], v4 offset:7168
  s_waitcnt lgkmcnt(0)
  v_mfma_f32_32x32x16_bf16 v[40:55], v[16:19], v[76:79], 0
  s_nop 11
  v_max3_f32 v1, v40, v41, v1
  v_max3_f32 v1, v42, v43, v1
  v_max3_f32 v1, v44, v45, v1
  v_max3_f32 v1, v46, v47, v1
  v_max3_f32 v1, v48, v49, v1
  v_max3_f32 v1, v50, v51, v1
  v_max3_f32 v1, v52, v53, v1
  v_max3_f32 v1, v54, v55, v1
L_fa45:
  v_mov_b32 v24, v1
  s_nop 1
  v_permlane32_swap_b32 v1, v24
  v_max_f32 v1, v1, v24
  v_sub_f32 v80, 0, v1
  v_sub_f32 v81, 0, v1
  v_sub_f32 v82, 0, v1
  v_sub_f32 v83, 0, v1
  v_sub_f32 v84, 0, v1
  v_sub_f32 v85, 0, v1
  v_sub_f32 v86, 0, v1
  v_sub_f32 v87, 0, v1
  v_sub_f32 v88, 0, v1
  v_sub_f32 v89, 0, v1
  v_sub_f32 v90, 0, v1
  v_sub_f32 v91, 0, v1
  v_sub_f32 v92, 0, v1
  v_sub_f32 v93, 0, v1
  v_sub_f32 v94, 0, v1
  v_sub_f32 v95, 0, v1
  v_mov_b32 v96, 0
  v_mov_b32 v97, 0
  v_mov_b32 v98, 0
  v_mov_b32 v99, 0
  v_mov_b32 v100, 0
  v_mov_b32 v101, 0
  v_mov_b32 v102, 0
  v_mov_b32 v103, 0
  v_mov_b32 v104, 0
  v_mov_b32 v105, 0
  v_mov_b32 v106, 0
  v_mov_b32 v107, 0
  v_mov_b32 v108, 0
  v_mov_b32 v109, 0
  v_mov_b32 v110, 0
  v_mov_b32 v111, 0
  v_mov_b32 v56, 0xf149f2ca
  v_mov_b32 v57, 0xf149f2ca
  v_mov_b32 v58, 0xf149f2ca
  v_mov_b32 v59, 0xf149f2ca
  v_mov_b32 v60, 0xf149f2ca
  v_mov_b32 v61, 0xf149f2ca
  v_mov_b32 v62, 0xf149f2ca
  v_mov_b32 v63, 0xf149f2ca
  v_mov_b32 v64, 0xf149f2ca
  v_mov_b32 v65, 0xf149f2ca
  v_mov_b32 v66, 0xf149f2ca
  v_mov_b32 v67, 0xf149f2ca
  v_mov_b32 v68, 0xf149f2ca
  v_mov_b32 v69, 0xf149f2ca
  v_mov_b32 v70, 0xf149f2ca
  v_mov_b32 v71, 0xf149f2ca
  s_cmp_gt_i32 s83, 0
  s_cbranch_scc1 L_fm46
  ds_read_b128 v[16:19], v4 offset:0
  s_waitcnt lgkmcnt(0)
  v_mfma_f32_32x32x16_bf16 v[56:71], v[16:19], v[76:79], v[80:95]
L_fm46:
  ds_read_b128 v[16:19], v4 offset:8192
  s_waitcnt lgkmcnt(0)
  v_mfma_f32_32x32x16_bf16 v[40:55], v[16:19], v[76:79], v[80:95]
  s_nop 11
  v_cndmask_b32 v40, v56, v40, s[4:5]
  v_cndmask_b32 v41, v57, v41, s[6:7]
  v_cndmask_b32 v42, v58, v42, s[8:9]
  v_cndmask_b32 v43, v59, v43, s[10:11]
  v_cndmask_b32 v44, v60, v44, s[12:13]
  v_cndmask_b32 v45, v61, v45, s[14:15]
  v_cndmask_b32 v46, v62, v46, s[16:17]
  v_cndmask_b32 v47, v63, v47, s[18:19]
  v_cndmask_b32 v48, v64, v48, s[20:21]
  v_cndmask_b32 v49, v65, v49, s[22:23]
  v_cndmask_b32 v50, v66, v50, s[40:41]
  v_cndmask_b32 v51, v67, v51, s[42:43]
  v_cndmask_b32 v52, v68, v52, s[44:45]
  v_cndmask_b32 v53, v69, v53, s[46:47]
  v_cndmask_b32 v54, v70, v54, s[64:65]
  v_cndmask_b32 v55, v71, v55, s[66:67]
  v_exp_f32 v40, v40
  v_exp_f32 v41, v41
  v_exp_f32 v42, v42
  v_exp_f32 v43, v43
  v_exp_f32 v44, v44
  v_exp_f32 v45, v45
  v_exp_f32 v46, v46
  v_exp_f32 v47, v47
  v_exp_f32 v48, v48
  v_exp_f32 v49, v49
  v_exp_f32 v50, v50
  v_exp_f32 v51, v51
  v_exp_f32 v52, v52
  v_exp_f32 v53, v53
  v_exp_f32 v54, v54
  v_exp_f32 v55, v55
  v_cndmask_b32 v56, 0, v40, s[4:5]
  v_cndmask_b32 v57, 0, v41, s[6:7]
  v_cndmask_b32 v58, 0, v42, s[8:9]
  v_cndmask_b32 v59, 0, v43, s[10:11]
  v_cndmask_b32 v60, 0, v44, s[12:13]
  v_cndmask_b32 v61, 0, v45, s[14:15]
  v_cndmask_b32 v62, 0, v46, s[16:17]
  v_cndmask_b32 v63, 0, v47, s[18:19]
  v_cndmask_b32 v64, 0, v48, s[20:21]
  v_cndmask_b32 v65, 0, v49, s[22:23]
  v_cndmask_b32 v66, 0, v50, s[40:41]
  v_cndmask_b32 v67, 0, v51, s[42:43]
  v_cndmask_b32 v68, 0, v52, s[44:45]
  v_cndmask_b32 v69, 0, v53, s[46:47]
  v_cndmask_b32 v70, 0, v54, s[64:65]
  v_cndmask_b32 v71, 0, v55, s[66:67]
  v_cvt_pk_bf16_f32 v32, v56, v57
  v_cvt_pk_bf16_f32 v33, v58, v59
  v_cvt_pk_bf16_f32 v34, v60, v61
  v_cvt_pk_bf16_f32 v35, v62, v63
  v_cvt_pk_bf16_f32 v36, v64, v65
  v_cvt_pk_bf16_f32 v37, v66, v67
  v_cvt_pk_bf16_f32 v38, v68, v69
  v_cvt_pk_bf16_f32 v39, v70, v71
  v_mul_u32_u24 v20, 8, v6
  v_add_u32 v20, v20, v5
  ds_read_b64_tr_b16 v[24:25], v20 offset:0
  ds_read_b64_tr_b16 v[26:27], v20 offset:256
  ds_read_b64_tr_b16 v[28:29], v20 offset:512
  ds_read_b64_tr_b16 v[30:31], v20 offset:768
  s_waitcnt lgkmcnt(0)
  v_mfma_f32_32x32x16_bf16 v[96:111], v[24:27], v[32:35], v[96:111]
  v_mfma_f32_32x32x16_bf16 v[96:111], v[28:31], v[36:39], v[96:111]
  v_cndmask_b32 v56, v40, 0, s[4:5]
  v_cndmask_b32 v57, v41, 0, s[6:7]
  v_cndmask_b32 v58, v42, 0, s[8:9]
  v_cndmask_b32 v59, v43, 0, s[10:11]
  v_cndmask_b32 v60, v44, 0, s[12:13]
  v_cndmask_b32 v61, v45, 0, s[14:15]
  v_cndmask_b32 v62, v46, 0, s[16:17]
  v_cndmask_b32 v63, v47, 0, s[18:19]
  v_cndmask_b32 v64, v48, 0, s[20:21]
  v_cndmask_b32 v65, v49, 0, s[22:23]
  v_cndmask_b32 v66, v50, 0, s[40:41]
  v_cndmask_b32 v67, v51, 0, s[42:43]
  v_cndmask_b32 v68, v52, 0, s[44:45]
  v_cndmask_b32 v69, v53, 0, s[46:47]
  v_cndmask_b32 v70, v54, 0, s[64:65]
  v_cndmask_b32 v71, v55, 0, s[66:67]
  v_cvt_pk_bf16_f32 v32, v56, v57
  v_cvt_pk_bf16_f32 v33, v58, v59
  v_cvt_pk_bf16_f32 v34, v60, v61
  v_cvt_pk_bf16_f32 v35, v62, v63
  v_cvt_pk_bf16_f32 v36, v64, v65
  v_cvt_pk_bf16_f32 v37, v66, v67
  v_cvt_pk_bf16_f32 v38, v68, v69
  v_cvt_pk_bf16_f32 v39, v70, v71
  v_mul_u32_u24 v20, 0, v6
  v_add_u32 v20, v20, v5
  ds_read_b64_tr_b16 v[24:25], v20 offset:0
  ds_read_b64_tr_b16 v[26:27], v20 offset:256
  ds_read_b64_tr_b16 v[28:29], v20 offset:512
  ds_read_b64_tr_b16 v[30:31], v20 offset:768
  s_waitcnt lgkmcnt(0)
  v_mfma_f32_32x32x16_bf16 v[96:111], v[24:27], v[32:35], v[96:111]
  v_mfma_f32_32x32x16_bf16 v[96:111], v[28:31], v[36:39], v[96:111]
  s_cmp_gt_i32 s83, 1
  s_cbranch_scc1 L_fc47
  ds_read_b128 v[16:19], v4 offset:1024
  s_waitcnt lgkmcnt(0)
  v_mfma_f32_32x32x16_bf16 v[40:55], v[16:19], v[76:79], v[80:95]
  s_nop 11
  v_exp_f32 v40, v40
  v_exp_f32 v41, v41
  v_exp_f32 v42, v42
  v_exp_f32 v43, v43
  v_exp_f32 v44, v44
  v_exp_f32 v45, v45
  v_exp_f32 v46, v46
  v_exp_f32 v47, v47
  v_exp_f32 v48, v48
  v_exp_f32 v49, v49
  v_exp_f32 v50, v50
  v_exp_f32 v51, v51
  v_exp_f32 v52, v52
  v_exp_f32 v53, v53
  v_exp_f32 v54, v54
  v_exp_f32 v55, v55
  v_cvt_pk_bf16_f32 v32, v40, v41
  v_cvt_pk_bf16_f32 v33, v42, v43
  v_cvt_pk_bf16_f32 v34, v44, v45
  v_cvt_pk_bf16_f32 v35, v46, v47
  v_cvt_pk_bf16_f32 v36, v48, v49
  v_cvt_pk_bf16_f32 v37, v50, v51
  v_cvt_pk_bf16_f32 v38, v52, v53
  v_cvt_pk_bf16_f32 v39, v54, v55
  v_mul_u32_u24 v20, 1, v6
  v_add_u32 v20, v20, v5
  ds_read_b64_tr_b16 v[24:25], v20 offset:0
  ds_read_b64_tr_b16 v[26:27], v20 offset:256
  ds_read_b64_tr_b16 v[28:29], v20 offset:512
  ds_read_b64_tr_b16 v[30:31], v20 offset:768
  s_waitcnt lgkmcnt(0)
  v_mfma_f32_32x32x16_bf16 v[96:111], v[24:27], v[32:35], v[96:111]
  v_mfma_f32_32x32x16_bf16 v[96:111], v[28:31], v[36:39], v[96:111]
L_fc47:
  s_cmp_gt_i32 s83, 2
  s_cbranch_scc1 L_fc48
  ds_read_b128 v[16:19], v4 offset:2048
  s_waitcnt lgkmcnt(0)
  v_mfma_f32_32x32x16_bf16 v[40:55], v[16:19], v[76:79], v[80:95]
  s_nop 11
  v_exp_f32 v40, v40
  v_exp_f32 v41, v41
  v_exp_f32 v42, v42
  v_exp_f32 v43, v43
  v_exp_f32 v44, v44
  v_exp_f32 v45, v45
  v_exp_f32 v46, v46
  v_exp_f32 v47, v47
  v_exp_f32 v48, v48
  v_exp_f32 v49, v49
  v_exp_f32 v50, v50
  v_exp_f32 v51, v51
  v_exp_f32 v52, v52
  v_exp_f32 v53, v53
  v_exp_f32 v54, v54
  v_exp_f32 v55, v55
  v_cvt_pk_bf16_f32 v32, v40, v41
  v_cvt_pk_bf16_f32 v33, v42, v43
  v_cvt_pk_bf16_f32 v34, v44, v45
  v_cvt_pk_bf16_f32 v35, v46, v47
  v_cvt_pk_bf16_f32 v36, v48, v49
  v_cvt_pk_bf16_f32 v37, v50, v51
  v_cvt_pk_bf16_f32 v38, v52, v53
  v_cvt_pk_bf16_f32 v39, v54, v55
  v_mul_u32_u24 v20, 2, v6
  v_add_u32 v20, v20, v5
  ds_read_b64_tr_b16 v[24:25], v20 offset:0
  ds_read_b64_tr_b16 v[26:27], v20 offset:256
  ds_read_b64_tr_b16 v[28:29], v20 offset:512
  ds_read_b64_tr_b16 v[30:31], v20 offset:768
  s_waitcnt lgkmcnt(0)
  v_mfma_f32_32x32x16_bf16 v[96:111], v[24:27], v[32:35], v[96:111]
  v_mfma_f32_32x32x16_bf16 v[96:111], v[28:31], v[36:39], v[96:111]
L_fc48:
  s_cmp_gt_i32 s83, 3
  s_cbranch_scc1 L_fc49
  ds_read_b128 v[16:19], v4 offset:3072
  s_waitcnt lgkmcnt(0)
  v_mfma_f32_32x32x16_bf16 v[40:55], v[16:19], v[76:79], v[80:95]
  s_nop 11
  v_exp_f32 v40, v40
  v_exp_f32 v41, v41
  v_exp_f32 v42, v42
  v_exp_f32 v43, v43
  v_exp_f32 v44, v44
  v_exp_f32 v45, v45
  v_exp_f32 v46, v46
  v_exp_f32 v47, v47
  v_exp_f32 v48, v48
  v_exp_f32 v49, v49
  v_exp_f32 v50, v50
  v_exp_f32 v51, v51
  v_exp_f32 v52, v52
  v_exp_f32 v53, v53
  v_exp_f32 v54, v54
  v_exp_f32 v55, v55
  v_cvt_pk_bf16_f32 v32, v40, v41
  v_cvt_pk_bf16_f32 v33, v42, v43
  v_cvt_pk_bf16_f32 v34, v44, v45
  v_cvt_pk_bf16_f32 v35, v46, v47
  v_cvt_pk_bf16_f32 v36, v48, v49
  v_cvt_pk_bf16_f32 v37, v50, v51
  v_cvt_pk_bf16_f32 v38, v52, v53
  v_cvt_pk_bf16_f32 v39, v54, v55
  v_mul_u32_u24 v20, 3, v6
  v_add_u32 v20, v20, v5
  ds_read_b64_tr_b16 v[24:25], v20 offset:0
  ds_read_b64_tr_b16 v[26:27], v20 offset:256
  ds_read_b64_tr_b16 v[28:29], v20 offset:512
  ds_read_b64_tr_b16 v[30:31], v20 offset:768
  s_waitcnt lgkmcnt(0)
  v_mfma_f32_32x32x16_bf16 v[96:111], v[24:27], v[32:35], v[96:111]
  v_mfma_f32_32x32x16_bf16 v[96:111], v[28:31], v[36:39], v[96:111]
L_fc49:
  s_cmp_gt_i32 s83, 4
  s_cbranch_scc1 L_fc50
  ds_read_b128 v[16:19], v4 offset:4096
  s_waitcnt lgkmcnt(0)
  v_mfma_f32_32x32x16_bf16 v[40:55], v[16:19], v[76:79], v[80:95]
  s_nop 11
  v_exp_f32 v40, v40
  v_exp_f32 v41, v41
  v_exp_f32 v42, v42
  v_exp_f32 v43, v43
  v_exp_f32 v44, v44
  v_exp_f32 v45, v45
  v_exp_f32 v46, v46
  v_exp_f32 v47, v47
  v_exp_f32 v48, v48
  v_exp_f32 v49, v49
  v_exp_f32 v50, v50
  v_exp_f32 v51, v51
  v_exp_f32 v52, v52
  v_exp_f32 v53, v53
  v_exp_f32 v54, v54
  v_exp_f32 v55, v55
  v_cvt_pk_bf16_f32 v32, v40, v41
  v_cvt_pk_bf16_f32 v33, v42, v43
  v_cvt_pk_bf16_f32 v34, v44, v45
  v_cvt_pk_bf16_f32 v35, v46, v47
  v_cvt_pk_bf16_f32 v36, v48, v49
  v_cvt_pk_bf16_f32 v37, v50, v51
  v_cvt_pk_bf16_f32 v38, v52, v53
  v_cvt_pk_bf16_f32 v39, v54, v55
  v_mul_u32_u24 v20, 4, v6
  v_add_u32 v20, v20, v5
  ds_read_b64_tr_b16 v[24:25], v20 offset:0
  ds_read_b64_tr_b16 v[26:27], v20 offset:256
  ds_read_b64_tr_b16 v[28:29], v20 offset:512
  ds_read_b64_tr_b16 v[30:31], v20 offset:768
  s_waitcnt lgkmcnt(0)
  v_mfma_f32_32x32x16_bf16 v[96:111], v[24:27], v[32:35], v[96:111]
  v_mfma_f32_32x32x16_bf16 v[96:111], v[28:31], v[36:39], v[96:111]
L_fc50:
  s_cmp_gt_i32 s83, 5
  s_cbranch_scc1 L_fc51
  ds_read_b128 v[16:19], v4 offset:5120
  s_waitcnt lgkmcnt(0)
  v_mfma_f32_32x32x16_bf16 v[40:55], v[16:19], v[76:79], v[80:95]
  s_nop 11
  v_exp_f32 v40, v40
  v_exp_f32 v41, v41
  v_exp_f32 v42, v42
  v_exp_f32 v43, v43
  v_exp_f32 v44, v44
  v_exp_f32 v45, v45
  v_exp_f32 v46, v46
  v_exp_f32 v47, v47
  v_exp_f32 v48, v48
  v_exp_f32 v49, v49
  v_exp_f32 v50, v50
  v_exp_f32 v51, v51
  v_exp_f32 v52, v52
  v_exp_f32 v53, v53
  v_exp_f32 v54, v54
  v_exp_f32 v55, v55
  v_cvt_pk_bf16_f32 v32, v40, v41
  v_cvt_pk_bf16_f32 v33, v42, v43
  v_cvt_pk_bf16_f32 v34, v44, v45
  v_cvt_pk_bf16_f32 v35, v46, v47
  v_cvt_pk_bf16_f32 v36, v48, v49
  v_cvt_pk_bf16_f32 v37, v50, v51
  v_cvt_pk_bf16_f32 v38, v52, v53
  v_cvt_pk_bf16_f32 v39, v54, v55
  v_mul_u32_u24 v20, 5, v6
  v_add_u32 v20, v20, v5
  ds_read_b64_tr_b16 v[24:25], v20 offset:0
  ds_read_b64_tr_b16 v[26:27], v20 offset:256
  ds_read_b64_tr_b16 v[28:29], v20 offset:512
  ds_read_b64_tr_b16 v[30:31], v20 offset:768
  s_waitcnt lgkmcnt(0)
  v_mfma_f32_32x32x16_bf16 v[96:111], v[24:27], v[32:35], v[96:111]
  v_mfma_f32_32x32x16_bf16 v[96:111], v[28:31], v[36:39], v[96:111]
L_fc51:
  s_cmp_gt_i32 s83, 6
  s_cbranch_scc1 L_fc52
  ds_read_b128 v[16:19], v4 offset:6144
  s_waitcnt lgkmcnt(0)
  v_mfma_f32_32x32x16_bf16 v[40:55], v[16:19], v[76:79], v[80:95]
  s_nop 11
  v_exp_f32 v40, v40
  v_exp_f32 v41, v41
  v_exp_f32 v42, v42
  v_exp_f32 v43, v43
  v_exp_f32 v44, v44
  v_exp_f32 v45, v45
  v_exp_f32 v46, v46
  v_exp_f32 v47, v47
  v_exp_f32 v48, v48
  v_exp_f32 v49, v49
  v_exp_f32 v50, v50
  v_exp_f32 v51, v51
  v_exp_f32 v52, v52
  v_exp_f32 v53, v53
  v_exp_f32 v54, v54
  v_exp_f32 v55, v55
  v_cvt_pk_bf16_f32 v32, v40, v41
  v_cvt_pk_bf16_f32 v33, v42, v43
  v_cvt_pk_bf16_f32 v34, v44, v45
  v_cvt_pk_bf16_f32 v35, v46, v47
  v_cvt_pk_bf16_f32 v36, v48, v49
  v_cvt_pk_bf16_f32 v37, v50, v51
  v_cvt_pk_bf16_f32 v38, v52, v53
  v_cvt_pk_bf16_f32 v39, v54, v55
  v_mul_u32_u24 v20, 6, v6
  v_add_u32 v20, v20, v5
  ds_read_b64_tr_b16 v[24:25], v20 offset:0
  ds_read_b64_tr_b16 v[26:27], v20 offset:256
  ds_read_b64_tr_b16 v[28:29], v20 offset:512
  ds_read_b64_tr_b16 v[30:31], v20 offset:768
  s_waitcnt lgkmcnt(0)
  v_mfma_f32_32x32x16_bf16 v[96:111], v[24:27], v[32:35], v[96:111]
  v_mfma_f32_32x32x16_bf16 v[96:111], v[28:31], v[36:39], v[96:111]
L_fc52:
  s_cmp_gt_i32 s83, 7
  s_cbranch_scc1 L_fc53
  ds_read_b128 v[16:19], v4 offset:7168
  s_waitcnt lgkmcnt(0)
  v_mfma_f32_32x32x16_bf16 v[40:55], v[16:19], v[76:79], v[80:95]
  s_nop 11
  v_exp_f32 v40, v40
  v_exp_f32 v41, v41
  v_exp_f32 v42, v42
  v_exp_f32 v43, v43
  v_exp_f32 v44, v44
  v_exp_f32 v45, v45
  v_exp_f32 v46, v46
  v_exp_f32 v47, v47
  v_exp_f32 v48, v48
  v_exp_f32 v49, v49
  v_exp_f32 v50, v50
  v_exp_f32 v51, v51
  v_exp_f32 v52, v52
  v_exp_f32 v53, v53
  v_exp_f32 v54, v54
  v_exp_f32 v55, v55
  v_cvt_pk_bf16_f32 v32, v40, v41
  v_cvt_pk_bf16_f32 v33, v42, v43
  v_cvt_pk_bf16_f32 v34, v44, v45
  v_cvt_pk_bf16_f32 v35, v46, v47
  v_cvt_pk_bf16_f32 v36, v48, v49
  v_cvt_pk_bf16_f32 v37, v50, v51
  v_cvt_pk_bf16_f32 v38, v52, v53
  v_cvt_pk_bf16_f32 v39, v54, v55
  v_mul_u32_u24 v20, 7, v6
  v_add_u32 v20, v20, v5
  ds_read_b64_tr_b16 v[24:25], v20 offset:0
  ds_read_b64_tr_b16 v[26:27], v20 offset:256
  ds_read_b64_tr_b16 v[28:29], v20 offset:512
  ds_read_b64_tr_b16 v[30:31], v20 offset:768
  s_waitcnt lgkmcnt(0)
  v_mfma_f32_32x32x16_bf16 v[96:111], v[24:27], v[32:35], v[96:111]
  v_mfma_f32_32x32x16_bf16 v[96:111], v[28:31], v[36:39], v[96:111]
L_fc53:
  s_nop 15
  s_cmp_eq_u32 s98, 0
  s_cbranch_scc1 L_fbd0
  s_branch L_fbd1
.section .rodata,"a"
.p2align 6
.amdhsa_kernel recurrent_scan__sliding_block__geglu_ffn__prompt_kernel
  .amdhsa_next_free_vgpr 256
  .amdhsa_next_free_sgpr 100
  .amdhsa_accum_offset 256
  .amdhsa_group_segment_fixed_size 0
  .amdhsa_kernarg_size 80
  .amdhsa_user_sgpr_count 2
  .amdhsa_user_sgpr_kernarg_segment_ptr 1
  .amdhsa_system_sgpr_workgroup_id_x 1
.end_amdhsa_kernel
```
